```python
import torch

def _softmax(x, axis=-1):
    return torch.softmax(x, dim=axis)
def _gelu(x):
    return torch.nn.functional.gelu(x, approximate="tanh")
def _silu(x):
    return torch.nn.functional.silu(x)
def _sigmoid(x):
    return torch.sigmoid(x)
def _layernorm(x, axis=-1, eps=1e-5):
    m = x.mean(dim=axis, keepdim=True)
    v = x.var(dim=axis, keepdim=True, unbiased=False)
    return (x - m) / torch.sqrt(v + eps)
def _scatter_add(tgt, idx, src, axis=0):
    return tgt.clone().index_add_(axis, idx, src)
def _segment_sum(src, seg, n):
    out = torch.zeros((n,) + src.shape[1:], dtype=src.dtype)
    return out.index_add_(0, seg, src)
def _pad(x, pw):
    flat = tuple(v for pair in reversed(pw) for v in pair)
    return torch.nn.functional.pad(x, flat)

kernel_name = 'parallel_sum__sliding_block__geglu_ffn__prompt'

def setup_inputs():

    _w = (lambda a: (lambda t: t.to(torch.bfloat16) if t.is_floating_point() else t)(torch.as_tensor(a)))
    def _A_setup():
        B, S, D = 1, 2048, 640
        return {
            "x": _w((lambda *s: torch.randn(*s, dtype=torch.bfloat16) * 0.05)(B, S, D)),
            "wqkv": _w((lambda *s: torch.randn(*s, dtype=torch.bfloat16) * 0.05)(D, 3 * D)),
            "wo": _w((lambda *s: torch.randn(*s, dtype=torch.bfloat16) * 0.05)(D, D)),
        }
    _A_in = _A_setup()

    def _B_setup():
        B, S, D, F = 1, 2048, 640, 1728
        return {
            "x": _w((lambda *s: torch.randn(*s, dtype=torch.bfloat16) * 0.05)(B, S, D)),
            "w_gate": _w((lambda *s: torch.randn(*s, dtype=torch.bfloat16) * 0.05)(D, F)),
            "w_up": _w((lambda *s: torch.randn(*s, dtype=torch.bfloat16) * 0.05)(D, F)),
            "w_down": _w((lambda *s: torch.randn(*s, dtype=torch.bfloat16) * 0.05)(F, D)),
        }
    _B_in = _B_setup()

    return {
        "A_x": _A_in["x"],
        "A_wqkv": _A_in["wqkv"],
        "A_wo": _A_in["wo"],
        "B_x": _B_in["x"],
        "B_w_gate": _B_in["w_gate"],
        "B_w_up": _B_in["w_up"],
        "B_w_down": _B_in["w_down"],
    }

def reference(A_x, A_wqkv, A_wo, B_x, B_w_gate, B_w_up, B_w_down):
    def _A_ref(x, wqkv, wo):
        B, S, D = x.shape
        H = 32; Dh = D // H; W = 256
        qkv = (lambda x, *d: x.permute(*d))((x @ wqkv).reshape(B, S, 3, H, Dh), 2, 0, 3, 1, 4)
        q, k, v = qkv[0], qkv[1], qkv[2]
        scores = torch.einsum("bhqd,bhkd->bhqk", q, k) * (Dh ** -0.5)
        idx = torch.arange(S)
        mask = (idx[:, None] - idx[None, :] >= 0) & (idx[:, None] - idx[None, :] < W)
        scores = torch.where(mask[None, None], scores, -1e9)
        p = _softmax(scores, axis=-1)
        o = torch.einsum("bhqk,bhkd->bhqd", p, v)
        return (lambda x, *d: x.permute(*d))(o, 0, 2, 1, 3).reshape(B, S, D) @ wo

    def _B_ref(x, w_gate, w_up, w_down):
        return (_gelu(x @ w_gate) * (x @ w_up)) @ w_down

    x = A_x
    xn = _layernorm(x, axis=-1)
    return x + _A_ref(xn, A_wqkv, A_wo) + _B_ref(xn, B_w_gate, B_w_up, B_w_down)
```

```asm
; @launch grid=(256,1,1) block=(512,1,1) lds=163840
.amdgcn_target "amdgcn-amd-amdhsa--gfx950"
.text
  .globl parallel_sum__sliding_block__geglu_ffn__prompt_kernel
  .p2align 8
  .type parallel_sum__sliding_block__geglu_ffn__prompt_kernel,@function
parallel_sum__sliding_block__geglu_ffn__prompt_kernel:
  s_cmp_ge_u32 s2, 16
  s_cbranch_scc1 K1_nocpf
  s_getpc_b64 s[36:37]
  v_lshlrev_b32 v2, 6, v0
  v_min_u32 v3, 4900, v2
  global_load_dword v202, v2, s[36:37]
  v_add_u32 v3, 0x8000, v3
  global_load_dword v203, v3, s[36:37]
K1_nocpf:
  s_cmp_ge_u32 s2, 256
  s_cbranch_scc1 K1_exit

  s_load_dwordx4 s[40:43], s[0:1], 0
  s_load_dwordx4 s[44:47], s[0:1], 32
  s_load_dwordx4 s[72:75], s[0:1], 64
  v_lshrrev_b32 v1, 6, v0
  v_and_b32 v207, 63, v0
  s_and_b32 s3, s2, 7
  v_readfirstlane_b32 s20, v1
  s_lshr_b32 s4, s2, 3
  s_and_b32 s5, s3, 1
  s_lshr_b32 s6, s3, 1
  s_and_b32 s7, s4, 3
  s_lshl_b32 s5, s5, 2
  s_add_u32 s5, s5, s7
  s_lshr_b32 s4, s4, 2
  s_lshl_b32 s21, s5, 8
  s_lshl_b32 s7, s20, 5
  s_add_u32 s21, s21, s7
  v_lshrrev_b32 v170, 3, v207
  v_add_u32 v170, s21, v170
  v_mul_u32_u24 v170, 1280, v170
  v_lshrrev_b32 v171, 4, v207
  v_xor_b32 v171, v171, v207
  v_and_b32 v171, 7, v171
  v_lshl_add_u32 v184, v171, 4, v170
  v_xor_b32 v185, 64, v184
  v_add_u32 v185, 10240, v185
  v_add_u32 v186, 20480, v184
  v_add_u32 v187, 20480, v185
  s_mov_b32 s50, s4
  s_mov_b32 s51, s6
  s_mov_b32 s57, s5
  s_lshl_b32 s7, s6, 3
  s_add_u32 s76, s7, s4
  s_mov_b32 s32, 0xffff0000
  s_waitcnt lgkmcnt(0)
  s_mov_b32 s48, s74
  s_mov_b32 s49, s75

  s_mov_b32 s8, s40
  s_mov_b32 s9, s41
  s_mov_b32 s10, 2621440
  s_mov_b32 s11, 0x20000
  s_cmp_lt_u32 s50, 3
  s_cbranch_scc0 K1_gu
  s_mul_i32 s51, s51, 3
  s_add_u32 s51, s51, s50
  s_mul_i32 s22, s51, 160
  s_mov_b32 s58, s51
  s_mov_b32 s59, s21
  s_lshl_b32 s27, s51, 3
  s_cmp_lt_u32 s51, 4
  s_cselect_b32 s23, 0x3ea52b5c, 1.0

  s_mov_b32 s12, s42
  s_mov_b32 s13, s43
  s_mov_b32 s14, 2457600
  s_mov_b32 s15, 0x20000
  s_add_u32 s16, s42, 160
  s_addc_u32 s17, s43, 0
  s_mov_b32 s18, 2457440
  s_mov_b32 s19, 0x20000
  s_mov_b32 s4, s48
  s_mov_b32 s5, s49
  s_mov_b32 s6, 9437184
  s_mov_b32 s7, 0x20000
  s_mul_i32 s24, s20, 12288
  s_mul_i32 s25, s20, 640
  s_add_u32 s25, s25, 98304
  v_lshrrev_b32 v170, 3, v207
  v_bfe_u32 v171, v207, 1, 2
  v_and_b32 v172, 1, v207
  s_lshl_b32 s26, s20, 2
  v_add_u32 v171, s26, v171
  v_mul_u32_u24 v171, 3840, v171
  v_lshlrev_b32 v170, 5, v170
  v_lshl_add_u32 v170, v172, 4, v170
  s_lshl_b32 s26, s22, 1
  v_add3_u32 v165, v170, v171, s26

  s_add_u32 m0, s25, 0
  s_mov_b32 s31, 0
  s_mov_b32 exec_hi, 255
  buffer_load_dwordx4 v165, s[12:15], s31 offen lds
  s_mov_b32 exec_hi, -1
  s_add_u32 m0, s25, 5248
  s_mov_b32 s31, 0
  s_mov_b32 exec_hi, 255
  buffer_load_dwordx4 v165, s[16:19], s31 offen lds
  s_mov_b32 exec_hi, -1
  s_add_u32 m0, s24, 0
  s_movk_i32 s30, 0
  buffer_load_dwordx4 v184, s[8:11], s30 offen lds
  s_add_u32 m0, s24, 1024
  s_movk_i32 s30, 0
  buffer_load_dwordx4 v185, s[8:11], s30 offen lds
  s_add_u32 m0, s24, 2048
  s_movk_i32 s30, 0
  buffer_load_dwordx4 v186, s[8:11], s30 offen lds
  s_add_u32 m0, s24, 3072
  s_movk_i32 s30, 0
  buffer_load_dwordx4 v187, s[8:11], s30 offen lds
  s_barrier
  s_add_u32 m0, s25, 12416
  s_mov_b32 s31, 122880
  s_mov_b32 exec_hi, 255
  buffer_load_dwordx4 v165, s[12:15], s31 offen lds
  s_mov_b32 exec_hi, -1
  s_add_u32 m0, s25, 17664
  s_mov_b32 s31, 122880
  s_mov_b32 exec_hi, 255
  buffer_load_dwordx4 v165, s[16:19], s31 offen lds
  s_mov_b32 exec_hi, -1
  v_and_b32 v170, 31, v207
  v_lshrrev_b32 v171, 5, v207
  v_bfe_u32 v172, v207, 1, 3
  v_xor_b32 v171, v171, v172
  v_lshlrev_b32 v170, 7, v170
  v_lshl_add_u32 v170, v171, 4, v170
  s_mul_i32 s26, s20, 12288
  v_add_u32 v188, s26, v170
  v_xor_b32 v189, 32, v188
  v_xor_b32 v190, 64, v188
  v_xor_b32 v191, 96, v188
  s_mov_b32 s68, s72
  s_mov_b32 s69, s73
  s_mov_b32 s70, 256
  s_mov_b32 s71, 0x20000
  s_add_u32 s64, s48, 25165824
  s_addc_u32 s65, s49, 0
  s_mov_b32 s66, 299008
  s_mov_b32 s67, 0x20000
  s_lshl_b32 s72, s57, 5
  s_add_u32 s72, s72, s76
  s_lshl_b32 s73, s72, 3
  s_add_u32 s73, s73, s20
  v_lshrrev_b32 v170, 5, v207
  v_bfe_u32 v171, v207, 4, 1
  v_and_b32 v172, 1, v207
  v_bfe_u32 v173, v207, 2, 2
  v_bfe_u32 v174, v207, 1, 1
  v_mul_u32_u24 v175, 5248, v172
  v_lshl_add_u32 v175, v171, 4, v175
  v_lshl_add_u32 v175, v173, 5, v175
  v_lshl_add_u32 v175, v174, 3, v175
  v_mul_u32_u24 v176, 1280, v170
  v_add_u32 v168, 98304, v175
  v_add_u32 v168, v176, v168
  s_lshr_b32 s56, s20, 2
  s_mul_i32 s26, s56, 0
  v_add_u32 v168, s26, v168
  s_waitcnt vmcnt(2) lgkmcnt(0)
  s_barrier
  ds_read_b128 v[96:99], v188 offset:0
  ds_read_b64_tr_b16 v[104:105], v168 offset:0
  ds_read_b64_tr_b16 v[106:107], v168 offset:640
  ds_read_b64_tr_b16 v[108:109], v168 offset:128
  ds_read_b64_tr_b16 v[110:111], v168 offset:768
  ds_read_b64_tr_b16 v[112:113], v168 offset:256
  ds_read_b64_tr_b16 v[114:115], v168 offset:896
  ds_read_b64_tr_b16 v[116:117], v168 offset:384
  ds_read_b64_tr_b16 v[118:119], v168 offset:1024
  ds_read_b64_tr_b16 v[120:121], v168 offset:512
  ds_read_b64_tr_b16 v[122:123], v168 offset:1152
  s_add_u32 m0, s24, 4096
  s_movk_i32 s30, 128
  buffer_load_dwordx4 v184, s[8:11], s30 offen lds
  s_add_u32 m0, s24, 5120
  s_movk_i32 s30, 128
  buffer_load_dwordx4 v185, s[8:11], s30 offen lds
  s_add_u32 m0, s25, 24832
  s_mov_b32 s31, 245760
  s_mov_b32 exec_hi, 255
  buffer_load_dwordx4 v165, s[12:15], s31 offen lds
  s_mov_b32 exec_hi, -1
  s_add_u32 m0, s25, 30080
  s_mov_b32 s31, 245760
  s_mov_b32 exec_hi, 255
  buffer_load_dwordx4 v165, s[16:19], s31 offen lds
  s_mov_b32 exec_hi, -1
  s_add_u32 m0, s24, 6144
  s_movk_i32 s30, 128
  buffer_load_dwordx4 v186, s[8:11], s30 offen lds
  s_add_u32 m0, s24, 7168
  s_movk_i32 s30, 128
  buffer_load_dwordx4 v187, s[8:11], s30 offen lds
  s_add_u32 m0, s25, 37248
  s_mov_b32 s31, 368640
  s_mov_b32 exec_hi, 255
  buffer_load_dwordx4 v165, s[12:15], s31 offen lds
  s_mov_b32 exec_hi, -1
  s_add_u32 m0, s25, 42496
  s_mov_b32 s31, 368640
  s_mov_b32 exec_hi, 255
  buffer_load_dwordx4 v165, s[16:19], s31 offen lds
  s_mov_b32 exec_hi, -1
  s_waitcnt lgkmcnt(0)
  v_mfma_f32_32x32x16_bf16 v[0:15], v[104:107], v[96:99], 0
  ds_read_b128 v[124:127], v189 offset:0
  ds_read_b64_tr_b16 v[132:133], v168 offset:2560
  ds_read_b64_tr_b16 v[134:135], v168 offset:3200
  ds_read_b64_tr_b16 v[136:137], v168 offset:2688
  v_mfma_f32_32x32x16_bf16 v[16:31], v[108:111], v[96:99], 0
  ds_read_b64_tr_b16 v[138:139], v168 offset:3328
  ds_read_b64_tr_b16 v[140:141], v168 offset:2816
  ds_read_b64_tr_b16 v[142:143], v168 offset:3456
  ds_read_b64_tr_b16 v[144:145], v168 offset:2944
  v_mfma_f32_32x32x16_bf16 v[32:47], v[112:115], v[96:99], 0
  ds_read_b64_tr_b16 v[146:147], v168 offset:3584
  ds_read_b64_tr_b16 v[148:149], v168 offset:3072
  ds_read_b64_tr_b16 v[150:151], v168 offset:3712
  s_add_u32 m0, s24, 8192
  s_movk_i32 s30, 256
  buffer_load_dwordx4 v184, s[8:11], s30 offen lds
  s_add_u32 m0, s24, 9216
  s_movk_i32 s30, 256
  buffer_load_dwordx4 v185, s[8:11], s30 offen lds
  v_mfma_f32_32x32x16_bf16 v[48:63], v[116:119], v[96:99], 0
  s_add_u32 m0, s25, 49664
  s_mov_b32 s31, 491520
  s_mov_b32 exec_hi, 255
  buffer_load_dwordx4 v165, s[12:15], s31 offen lds
  s_mov_b32 exec_hi, -1
  v_mfma_f32_32x32x16_bf16 v[64:79], v[120:123], v[96:99], 0
  s_add_u32 m0, s25, 54912
  s_mov_b32 s31, 491520
  s_mov_b32 exec_hi, 255
  buffer_load_dwordx4 v165, s[16:19], s31 offen lds
  s_mov_b32 exec_hi, -1
  s_waitcnt vmcnt(12) lgkmcnt(0)
  s_barrier
  v_mfma_f32_32x32x16_bf16 v[0:15], v[132:135], v[124:127], v[0:15]
  ds_read_b128 v[96:99], v190 offset:0
  ds_read_b64_tr_b16 v[104:105], v168 offset:12416
  ds_read_b64_tr_b16 v[106:107], v168 offset:13056
  ds_read_b64_tr_b16 v[108:109], v168 offset:12544
  v_mfma_f32_32x32x16_bf16 v[16:31], v[136:139], v[124:127], v[16:31]
  ds_read_b64_tr_b16 v[110:111], v168 offset:13184
  ds_read_b64_tr_b16 v[112:113], v168 offset:12672
  ds_read_b64_tr_b16 v[114:115], v168 offset:13312
  ds_read_b64_tr_b16 v[116:117], v168 offset:12800
  v_mfma_f32_32x32x16_bf16 v[32:47], v[140:143], v[124:127], v[32:47]
  ds_read_b64_tr_b16 v[118:119], v168 offset:13440
  ds_read_b64_tr_b16 v[120:121], v168 offset:12928
  ds_read_b64_tr_b16 v[122:123], v168 offset:13568
  s_add_u32 m0, s24, 10240
  s_movk_i32 s30, 256
  buffer_load_dwordx4 v186, s[8:11], s30 offen lds
  v_mfma_f32_32x32x16_bf16 v[48:63], v[144:147], v[124:127], v[48:63]
  s_add_u32 m0, s24, 11264
  s_movk_i32 s30, 256
  buffer_load_dwordx4 v187, s[8:11], s30 offen lds
  v_mfma_f32_32x32x16_bf16 v[64:79], v[148:151], v[124:127], v[64:79]
  s_waitcnt lgkmcnt(0)
  v_mfma_f32_32x32x16_bf16 v[0:15], v[104:107], v[96:99], v[0:15]
  ds_read_b128 v[124:127], v191 offset:0
  ds_read_b64_tr_b16 v[132:133], v168 offset:14976
  ds_read_b64_tr_b16 v[134:135], v168 offset:15616
  ds_read_b64_tr_b16 v[136:137], v168 offset:15104
  v_mfma_f32_32x32x16_bf16 v[16:31], v[108:111], v[96:99], v[16:31]
  ds_read_b64_tr_b16 v[138:139], v168 offset:15744
  ds_read_b64_tr_b16 v[140:141], v168 offset:15232
  ds_read_b64_tr_b16 v[142:143], v168 offset:15872
  ds_read_b64_tr_b16 v[144:145], v168 offset:15360
  v_mfma_f32_32x32x16_bf16 v[32:47], v[112:115], v[96:99], v[32:47]
  ds_read_b64_tr_b16 v[146:147], v168 offset:16000
  ds_read_b64_tr_b16 v[148:149], v168 offset:15488
  ds_read_b64_tr_b16 v[150:151], v168 offset:16128
  s_memrealtime s[80:81]
  s_or_b32 s26, s2, s20
  s_cmp_eq_u32 s26, 0
  s_cselect_b32 s26, 0, 0x40000000
  v_mov_b32 v171, 0
  s_waitcnt lgkmcnt(0)
  s_or_b32 s80, s80, 1
  v_mov_b32 v170, s80
  buffer_store_dword v170, v171, s[68:71], s26 offen sc1
  s_mul_i32 s26, s73, 1280
  v_mul_u32_u24 v157, 20, v207
  buffer_load_dwordx4 v[152:155], v157, s[8:11], s26 offen
  buffer_load_dword v156, v157, s[8:11], s26 offen offset:16
  v_and_b32 v170, 15, v207
  v_lshrrev_b32 v171, 4, v207
  s_and_b32 s3, s20, 3
  s_lshl_b32 s26, s3, 2
  s_mul_i32 s33, s57, 80
  s_add_u32 s26, s26, s33
  v_add_u32 v172, s26, v171
  v_mul_u32_u24 v172, 3840, v172
  v_lshl_add_u32 v172, v170, 4, v172
  s_lshl_b32 s26, s22, 1
  v_add_u32 v172, s26, v172
  v_cmp_gt_u32 vcc, 10, v170
  v_mov_b32 v173, 0x40000000
  s_cmp_eq_u32 s56, 0
  s_cselect_b32 s60, s12, s16
  s_cselect_b32 s61, s13, s17
  s_cselect_b32 s62, s14, s18
  v_mfma_f32_32x32x16_bf16 v[48:63], v[116:119], v[96:99], v[48:63]
  s_mov_b32 s63, 0x20000
  v_cndmask_b32 v172, v173, v172, vcc
  s_mov_b32 s26, 0
  buffer_load_dwordx4 v[208:211], v172, s[60:63], s26 offen
  s_mov_b32 s26, 61440
  buffer_load_dwordx4 v[212:215], v172, s[60:63], s26 offen
  s_mov_b32 s26, 122880
  buffer_load_dwordx4 v[216:219], v172, s[60:63], s26 offen
  s_mov_b32 s26, 184320
  buffer_load_dwordx4 v[220:223], v172, s[60:63], s26 offen
  s_mov_b32 s26, 245760
  buffer_load_dwordx4 v[224:227], v172, s[60:63], s26 offen
  v_lshrrev_b32 v172, 1, v170
  v_and_b32 v170, 1, v170
  v_lshlrev_b32 v172, 7, v172
  v_lshl_add_u32 v172, v170, 6, v172
  v_lshrrev_b32 v170, 1, v171
  v_lshl_add_u32 v172, v170, 5, v172
  v_and_b32 v170, 1, v171
  v_lshl_add_u32 v172, v170, 3, v172
  s_lshl_b32 s26, s56, 4
  s_mul_i32 s3, s3, 768
  s_add_u32 s26, s26, s3
  s_add_u32 s26, s26, 160384
  v_add_u32 v172, s26, v172
  v_mov_b32 v173, 163456
  v_cndmask_b32 v169, v173, v172, vcc
  s_mov_b32 s29, 0x3f803f80
  v_mfma_f32_32x32x16_bf16 v[64:79], v[120:123], v[96:99], v[64:79]
  s_add_u32 m0, s25, 0
  s_mov_b32 s31, 614400
  s_mov_b32 exec_hi, 255
  buffer_load_dwordx4 v165, s[12:15], s31 offen lds
  s_mov_b32 exec_hi, -1
  s_add_u32 m0, s25, 5248
  s_mov_b32 s31, 614400
  s_mov_b32 exec_hi, 255
  buffer_load_dwordx4 v165, s[16:19], s31 offen lds
  s_mov_b32 exec_hi, -1
  s_waitcnt vmcnt(18) lgkmcnt(0)
  s_barrier
  v_mfma_f32_32x32x16_bf16 v[0:15], v[132:135], v[124:127], v[0:15]
  ds_read_b128 v[96:99], v188 offset:4096
  ds_read_b64_tr_b16 v[104:105], v168 offset:24832
  ds_read_b64_tr_b16 v[106:107], v168 offset:25472
  ds_read_b64_tr_b16 v[108:109], v168 offset:24960
  v_mfma_f32_32x32x16_bf16 v[16:31], v[136:139], v[124:127], v[16:31]
  ds_read_b64_tr_b16 v[110:111], v168 offset:25600
  ds_read_b64_tr_b16 v[112:113], v168 offset:25088
  ds_read_b64_tr_b16 v[114:115], v168 offset:25728
  ds_read_b64_tr_b16 v[116:117], v168 offset:25216
  v_mfma_f32_32x32x16_bf16 v[32:47], v[140:143], v[124:127], v[32:47]
  ds_read_b64_tr_b16 v[118:119], v168 offset:25856
  ds_read_b64_tr_b16 v[120:121], v168 offset:25344
  ds_read_b64_tr_b16 v[122:123], v168 offset:25984
  s_add_u32 m0, s24, 0
  s_movk_i32 s30, 384
  buffer_load_dwordx4 v184, s[8:11], s30 offen lds
  v_mfma_f32_32x32x16_bf16 v[48:63], v[144:147], v[124:127], v[48:63]
  s_add_u32 m0, s24, 1024
  s_movk_i32 s30, 384
  buffer_load_dwordx4 v185, s[8:11], s30 offen lds
  v_mfma_f32_32x32x16_bf16 v[64:79], v[148:151], v[124:127], v[64:79]
  s_waitcnt lgkmcnt(0)
  v_mfma_f32_32x32x16_bf16 v[0:15], v[104:107], v[96:99], v[0:15]
  ds_read_b128 v[124:127], v189 offset:4096
  ds_read_b64_tr_b16 v[132:133], v168 offset:27392
  ds_read_b64_tr_b16 v[134:135], v168 offset:28032
  ds_read_b64_tr_b16 v[136:137], v168 offset:27520
  v_mfma_f32_32x32x16_bf16 v[16:31], v[108:111], v[96:99], v[16:31]
  ds_read_b64_tr_b16 v[138:139], v168 offset:28160
  ds_read_b64_tr_b16 v[140:141], v168 offset:27648
  ds_read_b64_tr_b16 v[142:143], v168 offset:28288
  ds_read_b64_tr_b16 v[144:145], v168 offset:27776
  v_mfma_f32_32x32x16_bf16 v[32:47], v[112:115], v[96:99], v[32:47]
  ds_read_b64_tr_b16 v[146:147], v168 offset:28416
  ds_read_b64_tr_b16 v[148:149], v168 offset:27904
  ds_read_b64_tr_b16 v[150:151], v168 offset:28544
  s_add_u32 m0, s25, 12416
  s_mov_b32 s31, 737280
  s_mov_b32 exec_hi, 255
  buffer_load_dwordx4 v165, s[12:15], s31 offen lds
  s_mov_b32 exec_hi, -1
  v_mfma_f32_32x32x16_bf16 v[48:63], v[116:119], v[96:99], v[48:63]
  s_add_u32 m0, s25, 17664
  s_mov_b32 s31, 737280
  s_mov_b32 exec_hi, 255
  buffer_load_dwordx4 v165, s[16:19], s31 offen lds
  s_mov_b32 exec_hi, -1
  v_mfma_f32_32x32x16_bf16 v[64:79], v[120:123], v[96:99], v[64:79]
  s_waitcnt vmcnt(20) lgkmcnt(0)
  s_barrier
  v_mfma_f32_32x32x16_bf16 v[0:15], v[132:135], v[124:127], v[0:15]
  ds_read_b128 v[96:99], v190 offset:4096
  ds_read_b64_tr_b16 v[104:105], v168 offset:37248
  ds_read_b64_tr_b16 v[106:107], v168 offset:37888
  ds_read_b64_tr_b16 v[108:109], v168 offset:37376
  v_mfma_f32_32x32x16_bf16 v[16:31], v[136:139], v[124:127], v[16:31]
  ds_read_b64_tr_b16 v[110:111], v168 offset:38016
  ds_read_b64_tr_b16 v[112:113], v168 offset:37504
  ds_read_b64_tr_b16 v[114:115], v168 offset:38144
  ds_read_b64_tr_b16 v[116:117], v168 offset:37632
  v_mfma_f32_32x32x16_bf16 v[32:47], v[140:143], v[124:127], v[32:47]
  ds_read_b64_tr_b16 v[118:119], v168 offset:38272
  ds_read_b64_tr_b16 v[120:121], v168 offset:37760
  ds_read_b64_tr_b16 v[122:123], v168 offset:38400
  s_add_u32 m0, s24, 2048
  s_movk_i32 s30, 384
  buffer_load_dwordx4 v186, s[8:11], s30 offen lds
  v_mfma_f32_32x32x16_bf16 v[48:63], v[144:147], v[124:127], v[48:63]
  s_add_u32 m0, s24, 3072
  s_movk_i32 s30, 384
  buffer_load_dwordx4 v187, s[8:11], s30 offen lds
  v_mfma_f32_32x32x16_bf16 v[64:79], v[148:151], v[124:127], v[64:79]
  s_waitcnt lgkmcnt(0)
  v_mfma_f32_32x32x16_bf16 v[0:15], v[104:107], v[96:99], v[0:15]
  ds_read_b128 v[124:127], v191 offset:4096
  ds_read_b64_tr_b16 v[132:133], v168 offset:39808
  ds_read_b64_tr_b16 v[134:135], v168 offset:40448
  ds_read_b64_tr_b16 v[136:137], v168 offset:39936
  v_mfma_f32_32x32x16_bf16 v[16:31], v[108:111], v[96:99], v[16:31]
  ds_read_b64_tr_b16 v[138:139], v168 offset:40576
  ds_read_b64_tr_b16 v[140:141], v168 offset:40064
  ds_read_b64_tr_b16 v[142:143], v168 offset:40704
  ds_read_b64_tr_b16 v[144:145], v168 offset:40192
  v_mfma_f32_32x32x16_bf16 v[32:47], v[112:115], v[96:99], v[32:47]
  ds_read_b64_tr_b16 v[146:147], v168 offset:40832
  ds_read_b64_tr_b16 v[148:149], v168 offset:40320
  ds_read_b64_tr_b16 v[150:151], v168 offset:40960
  s_add_u32 m0, s25, 24832
  s_mov_b32 s31, 860160
  s_mov_b32 exec_hi, 255
  buffer_load_dwordx4 v165, s[12:15], s31 offen lds
  s_mov_b32 exec_hi, -1
  v_mfma_f32_32x32x16_bf16 v[48:63], v[116:119], v[96:99], v[48:63]
  s_add_u32 m0, s25, 30080
  s_mov_b32 s31, 860160
  s_mov_b32 exec_hi, 255
  buffer_load_dwordx4 v165, s[16:19], s31 offen lds
  s_mov_b32 exec_hi, -1
  v_mfma_f32_32x32x16_bf16 v[64:79], v[120:123], v[96:99], v[64:79]
  s_waitcnt vmcnt(18) lgkmcnt(0)
  s_barrier
  v_mfma_f32_32x32x16_bf16 v[0:15], v[132:135], v[124:127], v[0:15]
  ds_read_b128 v[96:99], v188 offset:8192
  ds_read_b64_tr_b16 v[104:105], v168 offset:49664
  ds_read_b64_tr_b16 v[106:107], v168 offset:50304
  ds_read_b64_tr_b16 v[108:109], v168 offset:49792
  v_mfma_f32_32x32x16_bf16 v[16:31], v[136:139], v[124:127], v[16:31]
  ds_read_b64_tr_b16 v[110:111], v168 offset:50432
  ds_read_b64_tr_b16 v[112:113], v168 offset:49920
  ds_read_b64_tr_b16 v[114:115], v168 offset:50560
  ds_read_b64_tr_b16 v[116:117], v168 offset:50048
  v_mfma_f32_32x32x16_bf16 v[32:47], v[140:143], v[124:127], v[32:47]
  ds_read_b64_tr_b16 v[118:119], v168 offset:50688
  ds_read_b64_tr_b16 v[120:121], v168 offset:50176
  ds_read_b64_tr_b16 v[122:123], v168 offset:50816
  v_mov_b32 v201, 0
  buffer_load_dword v200, v201, s[68:71], 0 offen sc1
  v_mfma_f32_32x32x16_bf16 v[48:63], v[144:147], v[124:127], v[48:63]
  s_add_u32 m0, s24, 4096
  s_movk_i32 s30, 512
  buffer_load_dwordx4 v184, s[8:11], s30 offen lds
  v_mfma_f32_32x32x16_bf16 v[64:79], v[148:151], v[124:127], v[64:79]
  s_add_u32 m0, s24, 5120
  s_movk_i32 s30, 512
  buffer_load_dwordx4 v185, s[8:11], s30 offen lds
  s_waitcnt lgkmcnt(0)
  v_mfma_f32_32x32x16_bf16 v[0:15], v[104:107], v[96:99], v[0:15]
  ds_read_b128 v[124:127], v189 offset:8192
  ds_read_b64_tr_b16 v[132:133], v168 offset:52224
  ds_read_b64_tr_b16 v[134:135], v168 offset:52864
  ds_read_b64_tr_b16 v[136:137], v168 offset:52352
  v_mfma_f32_32x32x16_bf16 v[16:31], v[108:111], v[96:99], v[16:31]
  ds_read_b64_tr_b16 v[138:139], v168 offset:52992
  ds_read_b64_tr_b16 v[140:141], v168 offset:52480
  ds_read_b64_tr_b16 v[142:143], v168 offset:53120
  ds_read_b64_tr_b16 v[144:145], v168 offset:52608
  v_mfma_f32_32x32x16_bf16 v[32:47], v[112:115], v[96:99], v[32:47]
  ds_read_b64_tr_b16 v[146:147], v168 offset:53248
  ds_read_b64_tr_b16 v[148:149], v168 offset:52736
  ds_read_b64_tr_b16 v[150:151], v168 offset:53376
  s_add_u32 m0, s25, 37248
  s_mov_b32 s31, 983040
  s_mov_b32 exec_hi, 255
  buffer_load_dwordx4 v165, s[12:15], s31 offen lds
  s_mov_b32 exec_hi, -1
  v_mfma_f32_32x32x16_bf16 v[48:63], v[116:119], v[96:99], v[48:63]
  s_add_u32 m0, s25, 42496
  s_mov_b32 s31, 983040
  s_mov_b32 exec_hi, 255
  buffer_load_dwordx4 v165, s[16:19], s31 offen lds
  s_mov_b32 exec_hi, -1
  v_mfma_f32_32x32x16_bf16 v[64:79], v[120:123], v[96:99], v[64:79]
  s_waitcnt vmcnt(13) lgkmcnt(0)
  s_barrier
  v_mfma_f32_32x32x16_bf16 v[0:15], v[132:135], v[124:127], v[0:15]
  ds_read_b128 v[96:99], v190 offset:8192
  ds_read_b64_tr_b16 v[104:105], v168 offset:0
  ds_read_b64_tr_b16 v[106:107], v168 offset:640
  ds_read_b64_tr_b16 v[108:109], v168 offset:128
  v_mfma_f32_32x32x16_bf16 v[16:31], v[136:139], v[124:127], v[16:31]
  ds_read_b64_tr_b16 v[110:111], v168 offset:768
  ds_read_b64_tr_b16 v[112:113], v168 offset:256
  ds_read_b64_tr_b16 v[114:115], v168 offset:896
  ds_read_b64_tr_b16 v[116:117], v168 offset:384
  v_mfma_f32_32x32x16_bf16 v[32:47], v[140:143], v[124:127], v[32:47]
  ds_read_b64_tr_b16 v[118:119], v168 offset:1024
  ds_read_b64_tr_b16 v[120:121], v168 offset:512
  ds_read_b64_tr_b16 v[122:123], v168 offset:1152
  v_lshlrev_b32 v192, 16, v152
  v_and_b32 v193, s32, v152
  v_add_f32 v158, v192, v193
  v_mul_f32 v159, v192, v192
  v_fmac_f32 v159, v193, v193
  v_lshlrev_b32 v192, 16, v153
  v_and_b32 v193, s32, v153
  v_add_f32 v158, v158, v192
  v_fmac_f32 v159, v192, v192
  v_add_f32 v158, v158, v193
  v_fmac_f32 v159, v193, v193
  v_lshlrev_b32 v192, 16, v154
  v_and_b32 v193, s32, v154
  v_add_f32 v158, v158, v192
  v_mfma_f32_32x32x16_bf16 v[48:63], v[144:147], v[124:127], v[48:63]
  v_fmac_f32 v159, v192, v192
  v_add_f32 v158, v158, v193
  v_fmac_f32 v159, v193, v193
  v_lshlrev_b32 v192, 16, v155
  v_and_b32 v193, s32, v155
  v_add_f32 v158, v158, v192
  v_fmac_f32 v159, v192, v192
  s_add_u32 m0, s24, 6144
  s_movk_i32 s30, 512
  buffer_load_dwordx4 v186, s[8:11], s30 offen lds
  v_mfma_f32_32x32x16_bf16 v[64:79], v[148:151], v[124:127], v[64:79]
  s_add_u32 m0, s24, 7168
  s_movk_i32 s30, 512
  buffer_load_dwordx4 v187, s[8:11], s30 offen lds
  s_waitcnt lgkmcnt(0)
  v_mfma_f32_32x32x16_bf16 v[0:15], v[104:107], v[96:99], v[0:15]
  ds_read_b128 v[124:127], v191 offset:8192
  ds_read_b64_tr_b16 v[132:133], v168 offset:2560
  ds_read_b64_tr_b16 v[134:135], v168 offset:3200
  ds_read_b64_tr_b16 v[136:137], v168 offset:2688
  v_mfma_f32_32x32x16_bf16 v[16:31], v[108:111], v[96:99], v[16:31]
  ds_read_b64_tr_b16 v[138:139], v168 offset:3328
  ds_read_b64_tr_b16 v[140:141], v168 offset:2816
  ds_read_b64_tr_b16 v[142:143], v168 offset:3456
  ds_read_b64_tr_b16 v[144:145], v168 offset:2944
  v_mfma_f32_32x32x16_bf16 v[32:47], v[112:115], v[96:99], v[32:47]
  ds_read_b64_tr_b16 v[146:147], v168 offset:3584
  ds_read_b64_tr_b16 v[148:149], v168 offset:3072
  ds_read_b64_tr_b16 v[150:151], v168 offset:3712
  v_add_f32 v158, v158, v193
  v_fmac_f32 v159, v193, v193
  v_lshlrev_b32 v192, 16, v156
  v_and_b32 v193, s32, v156
  v_add_f32 v158, v158, v192
  v_fmac_f32 v159, v192, v192
  v_add_f32 v158, v158, v193
  v_fmac_f32 v159, v193, v193
  s_nop 1
  v_add_f32_dpp v158, v158, v158 row_shr:1 bound_ctrl:0
  v_add_f32_dpp v159, v159, v159 row_shr:1 bound_ctrl:0
  s_nop 1
  v_add_f32_dpp v158, v158, v158 row_shr:2 bound_ctrl:0
  v_add_f32_dpp v159, v159, v159 row_shr:2 bound_ctrl:0
  v_mfma_f32_32x32x16_bf16 v[48:63], v[116:119], v[96:99], v[48:63]
  s_nop 1
  v_add_f32_dpp v158, v158, v158 row_shr:4 bound_ctrl:0
  v_add_f32_dpp v159, v159, v159 row_shr:4 bound_ctrl:0
  s_nop 1
  v_add_f32_dpp v158, v158, v158 row_shr:8 bound_ctrl:0
  v_add_f32_dpp v159, v159, v159 row_shr:8 bound_ctrl:0
  s_nop 1
  s_add_u32 m0, s25, 49664
  s_mov_b32 s31, 1105920
  s_mov_b32 exec_hi, 255
  buffer_load_dwordx4 v165, s[12:15], s31 offen lds
  s_mov_b32 exec_hi, -1
  v_mfma_f32_32x32x16_bf16 v[64:79], v[120:123], v[96:99], v[64:79]
  s_add_u32 m0, s25, 54912
  s_mov_b32 s31, 1105920
  s_mov_b32 exec_hi, 255
  buffer_load_dwordx4 v165, s[16:19], s31 offen lds
  s_mov_b32 exec_hi, -1
  s_waitcnt vmcnt(11) lgkmcnt(0)
  s_barrier
  v_mfma_f32_32x32x16_bf16 v[0:15], v[132:135], v[124:127], v[0:15]
  ds_read_b128 v[96:99], v188 offset:0
  ds_read_b64_tr_b16 v[104:105], v168 offset:12416
  ds_read_b64_tr_b16 v[106:107], v168 offset:13056
  ds_read_b64_tr_b16 v[108:109], v168 offset:12544
  v_mfma_f32_32x32x16_bf16 v[16:31], v[136:139], v[124:127], v[16:31]
  ds_read_b64_tr_b16 v[110:111], v168 offset:13184
  ds_read_b64_tr_b16 v[112:113], v168 offset:12672
  ds_read_b64_tr_b16 v[114:115], v168 offset:13312
  ds_read_b64_tr_b16 v[116:117], v168 offset:12800
  v_mfma_f32_32x32x16_bf16 v[32:47], v[140:143], v[124:127], v[32:47]
  ds_read_b64_tr_b16 v[118:119], v168 offset:13440
  ds_read_b64_tr_b16 v[120:121], v168 offset:12928
  ds_read_b64_tr_b16 v[122:123], v168 offset:13568
  v_add_f32_dpp v158, v158, v158 row_bcast:15 row_mask:0xa
  v_add_f32_dpp v159, v159, v159 row_bcast:15 row_mask:0xa
  s_nop 1
  v_add_f32_dpp v158, v158, v158 row_bcast:31 row_mask:0xc
  v_add_f32_dpp v159, v159, v159 row_bcast:31 row_mask:0xc
  v_mul_f32 v158, 0xbacccccd, v158
  v_mul_f32 v159, 0x3acccccd, v159
  v_fma_f32 v159, -v158, v158, v159
  v_max_f32 v159, 0, v159
  v_add_f32 v159, 0x3727c5ac, v159
  v_rsq_f32 v159, v159
  v_cmp_eq_u32 vcc, 63, v207
  v_mov_b32 v192, 0x40000000
  s_lshl_b32 s26, s73, 3
  v_mfma_f32_32x32x16_bf16 v[48:63], v[144:147], v[124:127], v[48:63]
  v_cndmask_b32 v192, v192, 0, vcc
  buffer_store_dwordx2 v[158:159], v192, s[64:67], s26 offen sc1
  v_lshlrev_b32 v192, 16, v208
  v_lshlrev_b32 v171, 16, v212
  v_add_f32 v192, v192, v171
  v_lshlrev_b32 v170, 16, v216
  v_add_f32 v192, v192, v170
  s_add_u32 m0, s24, 8192
  s_movk_i32 s30, 640
  buffer_load_dwordx4 v184, s[8:11], s30 offen lds
  v_mfma_f32_32x32x16_bf16 v[64:79], v[148:151], v[124:127], v[64:79]
  s_add_u32 m0, s24, 9216
  s_movk_i32 s30, 640
  buffer_load_dwordx4 v185, s[8:11], s30 offen lds
  s_waitcnt lgkmcnt(0)
  v_mfma_f32_32x32x16_bf16 v[0:15], v[104:107], v[96:99], v[0:15]
  ds_read_b128 v[124:127], v189 offset:0
  ds_read_b64_tr_b16 v[132:133], v168 offset:14976
  ds_read_b64_tr_b16 v[134:135], v168 offset:15616
  ds_read_b64_tr_b16 v[136:137], v168 offset:15104
  v_mfma_f32_32x32x16_bf16 v[16:31], v[108:111], v[96:99], v[16:31]
  ds_read_b64_tr_b16 v[138:139], v168 offset:15744
  ds_read_b64_tr_b16 v[140:141], v168 offset:15232
  ds_read_b64_tr_b16 v[142:143], v168 offset:15872
  ds_read_b64_tr_b16 v[144:145], v168 offset:15360
  v_mfma_f32_32x32x16_bf16 v[32:47], v[112:115], v[96:99], v[32:47]
  ds_read_b64_tr_b16 v[146:147], v168 offset:16000
  ds_read_b64_tr_b16 v[148:149], v168 offset:15488
  ds_read_b64_tr_b16 v[150:151], v168 offset:16128
  v_lshlrev_b32 v171, 16, v220
  v_add_f32 v192, v192, v171
  v_lshlrev_b32 v170, 16, v224
  v_add_f32 v192, v192, v170
  v_and_b32 v193, s32, v208
  v_and_b32 v171, s32, v212
  v_add_f32 v193, v193, v171
  v_and_b32 v170, s32, v216
  v_add_f32 v193, v193, v170
  v_and_b32 v171, s32, v220
  v_add_f32 v193, v193, v171
  v_and_b32 v170, s32, v224
  v_add_f32 v193, v193, v170
  v_lshlrev_b32 v194, 16, v209
  v_mfma_f32_32x32x16_bf16 v[48:63], v[116:119], v[96:99], v[48:63]
  v_lshlrev_b32 v171, 16, v213
  v_add_f32 v194, v194, v171
  v_lshlrev_b32 v170, 16, v217
  v_add_f32 v194, v194, v170
  v_lshlrev_b32 v171, 16, v221
  v_add_f32 v194, v194, v171
  v_lshlrev_b32 v170, 16, v225
  s_add_u32 m0, s25, 0
  s_mov_b32 s31, 1228800
  s_mov_b32 exec_hi, 255
  buffer_load_dwordx4 v165, s[12:15], s31 offen lds
  s_mov_b32 exec_hi, -1
  v_mfma_f32_32x32x16_bf16 v[64:79], v[120:123], v[96:99], v[64:79]
  s_add_u32 m0, s25, 5248
  s_mov_b32 s31, 1228800
  s_mov_b32 exec_hi, 255
  buffer_load_dwordx4 v165, s[16:19], s31 offen lds
  s_mov_b32 exec_hi, -1
  s_waitcnt vmcnt(14) lgkmcnt(0)
  s_barrier
  v_mfma_f32_32x32x16_bf16 v[0:15], v[132:135], v[124:127], v[0:15]
  ds_read_b128 v[96:99], v190 offset:0
  ds_read_b64_tr_b16 v[104:105], v168 offset:24832
  ds_read_b64_tr_b16 v[106:107], v168 offset:25472
  ds_read_b64_tr_b16 v[108:109], v168 offset:24960
  v_mfma_f32_32x32x16_bf16 v[16:31], v[136:139], v[124:127], v[16:31]
  ds_read_b64_tr_b16 v[110:111], v168 offset:25600
  ds_read_b64_tr_b16 v[112:113], v168 offset:25088
  ds_read_b64_tr_b16 v[114:115], v168 offset:25728
  ds_read_b64_tr_b16 v[116:117], v168 offset:25216
  v_mfma_f32_32x32x16_bf16 v[32:47], v[140:143], v[124:127], v[32:47]
  ds_read_b64_tr_b16 v[118:119], v168 offset:25856
  ds_read_b64_tr_b16 v[120:121], v168 offset:25344
  ds_read_b64_tr_b16 v[122:123], v168 offset:25984
  v_add_f32 v194, v194, v170
  v_and_b32 v195, s32, v209
  v_and_b32 v171, s32, v213
  v_add_f32 v195, v195, v171
  v_and_b32 v170, s32, v217
  v_add_f32 v195, v195, v170
  v_and_b32 v171, s32, v221
  v_add_f32 v195, v195, v171
  v_and_b32 v170, s32, v225
  v_add_f32 v195, v195, v170
  v_lshlrev_b32 v196, 16, v210
  v_lshlrev_b32 v171, 16, v214
  v_add_f32 v196, v196, v171
  v_lshlrev_b32 v170, 16, v218
  v_mfma_f32_32x32x16_bf16 v[48:63], v[144:147], v[124:127], v[48:63]
  v_add_f32 v196, v196, v170
  v_lshlrev_b32 v171, 16, v222
  v_add_f32 v196, v196, v171
  v_lshlrev_b32 v170, 16, v226
  v_add_f32 v196, v196, v170
  v_and_b32 v197, s32, v210
  v_and_b32 v171, s32, v214
  s_add_u32 m0, s24, 10240
  s_movk_i32 s30, 640
  buffer_load_dwordx4 v186, s[8:11], s30 offen lds
  v_mfma_f32_32x32x16_bf16 v[64:79], v[148:151], v[124:127], v[64:79]
  s_add_u32 m0, s24, 11264
  s_movk_i32 s30, 640
  buffer_load_dwordx4 v187, s[8:11], s30 offen lds
  s_waitcnt lgkmcnt(0)
  v_mfma_f32_32x32x16_bf16 v[0:15], v[104:107], v[96:99], v[0:15]
  ds_read_b128 v[124:127], v191 offset:0
  ds_read_b64_tr_b16 v[132:133], v168 offset:27392
  ds_read_b64_tr_b16 v[134:135], v168 offset:28032
  ds_read_b64_tr_b16 v[136:137], v168 offset:27520
  v_mfma_f32_32x32x16_bf16 v[16:31], v[108:111], v[96:99], v[16:31]
  ds_read_b64_tr_b16 v[138:139], v168 offset:28160
  ds_read_b64_tr_b16 v[140:141], v168 offset:27648
  ds_read_b64_tr_b16 v[142:143], v168 offset:28288
  ds_read_b64_tr_b16 v[144:145], v168 offset:27776
  v_mfma_f32_32x32x16_bf16 v[32:47], v[112:115], v[96:99], v[32:47]
  ds_read_b64_tr_b16 v[146:147], v168 offset:28416
  ds_read_b64_tr_b16 v[148:149], v168 offset:27904
  ds_read_b64_tr_b16 v[150:151], v168 offset:28544
  v_add_f32 v197, v197, v171
  v_and_b32 v170, s32, v218
  v_add_f32 v197, v197, v170
  v_and_b32 v171, s32, v222
  v_add_f32 v197, v197, v171
  v_and_b32 v170, s32, v226
  v_add_f32 v197, v197, v170
  v_lshlrev_b32 v198, 16, v211
  v_lshlrev_b32 v171, 16, v215
  v_add_f32 v198, v198, v171
  v_lshlrev_b32 v170, 16, v219
  v_add_f32 v198, v198, v170
  v_lshlrev_b32 v171, 16, v223
  v_add_f32 v198, v198, v171
  v_mfma_f32_32x32x16_bf16 v[48:63], v[116:119], v[96:99], v[48:63]
  v_lshlrev_b32 v170, 16, v227
  v_add_f32 v198, v198, v170
  v_and_b32 v199, s32, v211
  v_and_b32 v171, s32, v215
  v_add_f32 v199, v199, v171
  v_and_b32 v170, s32, v219
  v_add_f32 v199, v199, v170
  s_add_u32 m0, s25, 12416
  s_mov_b32 s31, 1351680
  s_mov_b32 exec_hi, 255
  buffer_load_dwordx4 v165, s[12:15], s31 offen lds
  s_mov_b32 exec_hi, -1
  v_mfma_f32_32x32x16_bf16 v[64:79], v[120:123], v[96:99], v[64:79]
  s_add_u32 m0, s25, 17664
  s_mov_b32 s31, 1351680
  s_mov_b32 exec_hi, 255
  buffer_load_dwordx4 v165, s[16:19], s31 offen lds
  s_mov_b32 exec_hi, -1
  s_waitcnt vmcnt(11) lgkmcnt(0)
  s_barrier
  v_mfma_f32_32x32x16_bf16 v[0:15], v[132:135], v[124:127], v[0:15]
  ds_read_b128 v[96:99], v188 offset:4096
  ds_read_b64_tr_b16 v[104:105], v168 offset:37248
  ds_read_b64_tr_b16 v[106:107], v168 offset:37888
  ds_read_b64_tr_b16 v[108:109], v168 offset:37376
  v_mfma_f32_32x32x16_bf16 v[16:31], v[136:139], v[124:127], v[16:31]
  ds_read_b64_tr_b16 v[110:111], v168 offset:38016
  ds_read_b64_tr_b16 v[112:113], v168 offset:37504
  ds_read_b64_tr_b16 v[114:115], v168 offset:38144
  ds_read_b64_tr_b16 v[116:117], v168 offset:37632
  v_mfma_f32_32x32x16_bf16 v[32:47], v[140:143], v[124:127], v[32:47]
  ds_read_b64_tr_b16 v[118:119], v168 offset:38272
  ds_read_b64_tr_b16 v[120:121], v168 offset:37760
  ds_read_b64_tr_b16 v[122:123], v168 offset:38400
  v_and_b32 v171, s32, v223
  v_add_f32 v199, v199, v171
  v_and_b32 v170, s32, v227
  v_add_f32 v199, v199, v170
  s_nop 1
  v_permlane32_swap_b32 v192, v196
  v_permlane32_swap_b32 v193, v197
  v_permlane32_swap_b32 v194, v198
  v_permlane32_swap_b32 v195, v199
  s_nop 1
  v_add_f32 v192, v192, v196
  v_add_f32 v193, v193, v197
  v_add_f32 v194, v194, v198
  v_add_f32 v195, v195, v199
  v_mfma_f32_32x32x16_bf16 v[48:63], v[144:147], v[124:127], v[48:63]
  s_nop 1
  v_permlane16_swap_b32 v192, v194
  v_permlane16_swap_b32 v193, v195
  s_nop 1
  v_add_f32 v192, v192, v194
  v_add_f32 v193, v193, v195
  ds_write_b64 v169, v[192:193]
  s_add_u32 m0, s24, 0
  s_movk_i32 s30, 768
  buffer_load_dwordx4 v184, s[8:11], s30 offen lds
  v_mfma_f32_32x32x16_bf16 v[64:79], v[148:151], v[124:127], v[64:79]
  s_add_u32 m0, s24, 1024
  s_movk_i32 s30, 768
  buffer_load_dwordx4 v185, s[8:11], s30 offen lds
  s_waitcnt lgkmcnt(0)
  v_mfma_f32_32x32x16_bf16 v[0:15], v[104:107], v[96:99], v[0:15]
  ds_read_b128 v[124:127], v189 offset:4096
  ds_read_b64_tr_b16 v[132:133], v168 offset:39808
  ds_read_b64_tr_b16 v[134:135], v168 offset:40448
  ds_read_b64_tr_b16 v[136:137], v168 offset:39936
  v_mfma_f32_32x32x16_bf16 v[16:31], v[108:111], v[96:99], v[16:31]
  ds_read_b64_tr_b16 v[138:139], v168 offset:40576
  ds_read_b64_tr_b16 v[140:141], v168 offset:40064
  ds_read_b64_tr_b16 v[142:143], v168 offset:40704
  ds_read_b64_tr_b16 v[144:145], v168 offset:40192
  v_mfma_f32_32x32x16_bf16 v[32:47], v[112:115], v[96:99], v[32:47]
  ds_read_b64_tr_b16 v[146:147], v168 offset:40832
  ds_read_b64_tr_b16 v[148:149], v168 offset:40320
  ds_read_b64_tr_b16 v[150:151], v168 offset:40960
  s_add_u32 m0, s25, 24832
  s_mov_b32 s31, 1474560
  s_mov_b32 exec_hi, 255
  buffer_load_dwordx4 v165, s[12:15], s31 offen lds
  s_mov_b32 exec_hi, -1
  v_mfma_f32_32x32x16_bf16 v[48:63], v[116:119], v[96:99], v[48:63]
  s_add_u32 m0, s25, 30080
  s_mov_b32 s31, 1474560
  s_mov_b32 exec_hi, 255
  buffer_load_dwordx4 v165, s[16:19], s31 offen lds
  s_mov_b32 exec_hi, -1
  v_mfma_f32_32x32x16_bf16 v[64:79], v[120:123], v[96:99], v[64:79]
  s_waitcnt vmcnt(13) lgkmcnt(0)
  s_barrier
  v_mfma_f32_32x32x16_bf16 v[0:15], v[132:135], v[124:127], v[0:15]
  ds_read_b128 v[96:99], v190 offset:4096
  ds_read_b64_tr_b16 v[104:105], v168 offset:49664
  ds_read_b64_tr_b16 v[106:107], v168 offset:50304
  ds_read_b64_tr_b16 v[108:109], v168 offset:49792
  v_mfma_f32_32x32x16_bf16 v[16:31], v[136:139], v[124:127], v[16:31]
  ds_read_b64_tr_b16 v[110:111], v168 offset:50432
  ds_read_b64_tr_b16 v[112:113], v168 offset:49920
  ds_read_b64_tr_b16 v[114:115], v168 offset:50560
  ds_read_b64_tr_b16 v[116:117], v168 offset:50048
  v_mfma_f32_32x32x16_bf16 v[32:47], v[140:143], v[124:127], v[32:47]
  ds_read_b64_tr_b16 v[118:119], v168 offset:50688
  ds_read_b64_tr_b16 v[120:121], v168 offset:50176
  ds_read_b64_tr_b16 v[122:123], v168 offset:50816
  v_lshl_add_u32 v192, s20, 6, v207
  v_cmp_gt_u32 vcc, 192, v192
  v_lshlrev_b32 v192, 2, v192
  v_add_u32 v193, 160384, v192
  ds_read_b32 v194, v193
  ds_read_b32 v195, v193 offset:768
  ds_read_b32 v196, v193 offset:1536
  ds_read_b32 v197, v193 offset:2304
  v_mov_b32 v193, 0x40000000
  s_lshl_b32 s26, s58, 3
  s_add_u32 s26, s26, s57
  s_mul_i32 s33, s26, 768
  s_add_u32 s33, s33, 114688
  v_cndmask_b32 v192, v193, v192, vcc
  v_mfma_f32_32x32x16_bf16 v[48:63], v[144:147], v[124:127], v[48:63]
  s_add_u32 m0, s24, 2048
  s_movk_i32 s30, 768
  buffer_load_dwordx4 v186, s[8:11], s30 offen lds
  v_mfma_f32_32x32x16_bf16 v[64:79], v[148:151], v[124:127], v[64:79]
  s_add_u32 m0, s24, 3072
  s_movk_i32 s30, 768
  buffer_load_dwordx4 v187, s[8:11], s30 offen lds
  s_waitcnt lgkmcnt(0)
  v_mfma_f32_32x32x16_bf16 v[0:15], v[104:107], v[96:99], v[0:15]
  ds_read_b128 v[124:127], v191 offset:4096
  ds_read_b64_tr_b16 v[132:133], v168 offset:52224
  ds_read_b64_tr_b16 v[134:135], v168 offset:52864
  ds_read_b64_tr_b16 v[136:137], v168 offset:52352
  v_mfma_f32_32x32x16_bf16 v[16:31], v[108:111], v[96:99], v[16:31]
  ds_read_b64_tr_b16 v[138:139], v168 offset:52992
  ds_read_b64_tr_b16 v[140:141], v168 offset:52480
  ds_read_b64_tr_b16 v[142:143], v168 offset:53120
  ds_read_b64_tr_b16 v[144:145], v168 offset:52608
  v_mfma_f32_32x32x16_bf16 v[32:47], v[112:115], v[96:99], v[32:47]
  ds_read_b64_tr_b16 v[146:147], v168 offset:53248
  ds_read_b64_tr_b16 v[148:149], v168 offset:52736
  ds_read_b64_tr_b16 v[150:151], v168 offset:53376
  v_add_f32 v194, v194, v195
  v_add_f32 v196, v196, v197
  v_add_f32 v194, v194, v196
  buffer_store_dword v194, v192, s[64:67], s33 offen sc1
  v_mfma_f32_32x32x16_bf16 v[48:63], v[116:119], v[96:99], v[48:63]
  s_add_u32 m0, s25, 37248
  s_mov_b32 s31, 1597440
  s_mov_b32 exec_hi, 255
  buffer_load_dwordx4 v165, s[12:15], s31 offen lds
  s_mov_b32 exec_hi, -1
  v_mfma_f32_32x32x16_bf16 v[64:79], v[120:123], v[96:99], v[64:79]
  s_add_u32 m0, s25, 42496
  s_mov_b32 s31, 1597440
  s_mov_b32 exec_hi, 255
  buffer_load_dwordx4 v165, s[16:19], s31 offen lds
  s_mov_b32 exec_hi, -1
  s_waitcnt vmcnt(11) lgkmcnt(0)
  s_barrier
  v_mfma_f32_32x32x16_bf16 v[0:15], v[132:135], v[124:127], v[0:15]
  ds_read_b128 v[96:99], v188 offset:8192
  ds_read_b64_tr_b16 v[104:105], v168 offset:0
  ds_read_b64_tr_b16 v[106:107], v168 offset:640
  ds_read_b64_tr_b16 v[108:109], v168 offset:128
  v_mfma_f32_32x32x16_bf16 v[16:31], v[136:139], v[124:127], v[16:31]
  ds_read_b64_tr_b16 v[110:111], v168 offset:768
  ds_read_b64_tr_b16 v[112:113], v168 offset:256
  ds_read_b64_tr_b16 v[114:115], v168 offset:896
  ds_read_b64_tr_b16 v[116:117], v168 offset:384
  v_mfma_f32_32x32x16_bf16 v[32:47], v[140:143], v[124:127], v[32:47]
  ds_read_b64_tr_b16 v[118:119], v168 offset:1024
  ds_read_b64_tr_b16 v[120:121], v168 offset:512
  ds_read_b64_tr_b16 v[122:123], v168 offset:1152
  v_readfirstlane_b32 s82, v200
  s_cmp_lg_u32 s82, 0
  s_cbranch_scc1 NGQ_done
  v_mov_b32 v192, 0
  s_mov_b32 s26, 0x100000
NGQ_loop:
  buffer_load_dword v193, v192, s[68:71], 0 offen sc1
  s_sub_u32 s26, s26, 1
  s_cbranch_scc1 NGQ_done
  s_waitcnt vmcnt(0)
  v_readfirstlane_b32 s82, v193
  s_cmp_eq_u32 s82, 0
  s_cbranch_scc1 NGQ_loop
NGQ_done:
  v_mfma_f32_32x32x16_bf16 v[48:63], v[144:147], v[124:127], v[48:63]
  s_add_u32 m0, s24, 4096
  s_movk_i32 s30, 896
  buffer_load_dwordx4 v184, s[8:11], s30 offen lds
  v_mfma_f32_32x32x16_bf16 v[64:79], v[148:151], v[124:127], v[64:79]
  s_add_u32 m0, s24, 5120
  s_movk_i32 s30, 896
  buffer_load_dwordx4 v185, s[8:11], s30 offen lds
  s_waitcnt lgkmcnt(0)
  v_mfma_f32_32x32x16_bf16 v[0:15], v[104:107], v[96:99], v[0:15]
  ds_read_b128 v[124:127], v189 offset:8192
  ds_read_b64_tr_b16 v[132:133], v168 offset:2560
  ds_read_b64_tr_b16 v[134:135], v168 offset:3200
  ds_read_b64_tr_b16 v[136:137], v168 offset:2688
  v_mfma_f32_32x32x16_bf16 v[16:31], v[108:111], v[96:99], v[16:31]
  ds_read_b64_tr_b16 v[138:139], v168 offset:3328
  ds_read_b64_tr_b16 v[140:141], v168 offset:2816
  ds_read_b64_tr_b16 v[142:143], v168 offset:3456
  ds_read_b64_tr_b16 v[144:145], v168 offset:2944
  v_mfma_f32_32x32x16_bf16 v[32:47], v[112:115], v[96:99], v[32:47]
  ds_read_b64_tr_b16 v[146:147], v168 offset:3584
  ds_read_b64_tr_b16 v[148:149], v168 offset:3072
  ds_read_b64_tr_b16 v[150:151], v168 offset:3712
  s_add_u32 m0, s25, 49664
  s_mov_b32 s31, 1720320
  s_mov_b32 exec_hi, 255
  buffer_load_dwordx4 v165, s[12:15], s31 offen lds
  s_mov_b32 exec_hi, -1
  v_mfma_f32_32x32x16_bf16 v[48:63], v[116:119], v[96:99], v[48:63]
  s_add_u32 m0, s25, 54912
  s_mov_b32 s31, 1720320
  s_mov_b32 exec_hi, 255
  buffer_load_dwordx4 v165, s[16:19], s31 offen lds
  s_mov_b32 exec_hi, -1
  v_mfma_f32_32x32x16_bf16 v[64:79], v[120:123], v[96:99], v[64:79]
  s_waitcnt vmcnt(13) lgkmcnt(0)
  s_barrier
  v_mfma_f32_32x32x16_bf16 v[0:15], v[132:135], v[124:127], v[0:15]
  ds_read_b128 v[96:99], v190 offset:8192
  ds_read_b64_tr_b16 v[104:105], v168 offset:12416
  ds_read_b64_tr_b16 v[106:107], v168 offset:13056
  ds_read_b64_tr_b16 v[108:109], v168 offset:12544
  v_mfma_f32_32x32x16_bf16 v[16:31], v[136:139], v[124:127], v[16:31]
  ds_read_b64_tr_b16 v[110:111], v168 offset:13184
  ds_read_b64_tr_b16 v[112:113], v168 offset:12672
  ds_read_b64_tr_b16 v[114:115], v168 offset:13312
  ds_read_b64_tr_b16 v[116:117], v168 offset:12800
  v_mfma_f32_32x32x16_bf16 v[32:47], v[140:143], v[124:127], v[32:47]
  ds_read_b64_tr_b16 v[118:119], v168 offset:13440
  ds_read_b64_tr_b16 v[120:121], v168 offset:12928
  ds_read_b64_tr_b16 v[122:123], v168 offset:13568
  s_add_u32 m0, s24, 6144
  s_movk_i32 s30, 896
  buffer_load_dwordx4 v186, s[8:11], s30 offen lds
  v_mfma_f32_32x32x16_bf16 v[48:63], v[144:147], v[124:127], v[48:63]
  s_add_u32 m0, s24, 7168
  s_movk_i32 s30, 896
  buffer_load_dwordx4 v187, s[8:11], s30 offen lds
  v_mfma_f32_32x32x16_bf16 v[64:79], v[148:151], v[124:127], v[64:79]
  s_waitcnt lgkmcnt(0)
  v_mfma_f32_32x32x16_bf16 v[0:15], v[104:107], v[96:99], v[0:15]
  ds_read_b128 v[124:127], v191 offset:8192
  ds_read_b64_tr_b16 v[132:133], v168 offset:14976
  ds_read_b64_tr_b16 v[134:135], v168 offset:15616
  ds_read_b64_tr_b16 v[136:137], v168 offset:15104
  v_mfma_f32_32x32x16_bf16 v[16:31], v[108:111], v[96:99], v[16:31]
  ds_read_b64_tr_b16 v[138:139], v168 offset:15744
  ds_read_b64_tr_b16 v[140:141], v168 offset:15232
  ds_read_b64_tr_b16 v[142:143], v168 offset:15872
  ds_read_b64_tr_b16 v[144:145], v168 offset:15360
  v_mfma_f32_32x32x16_bf16 v[32:47], v[112:115], v[96:99], v[32:47]
  ds_read_b64_tr_b16 v[146:147], v168 offset:16000
  ds_read_b64_tr_b16 v[148:149], v168 offset:15488
  ds_read_b64_tr_b16 v[150:151], v168 offset:16128
  s_add_u32 m0, s25, 0
  s_mov_b32 s31, 1843200
  s_mov_b32 exec_hi, 255
  buffer_load_dwordx4 v165, s[12:15], s31 offen lds
  s_mov_b32 exec_hi, -1
  v_mfma_f32_32x32x16_bf16 v[48:63], v[116:119], v[96:99], v[48:63]
  s_add_u32 m0, s25, 5248
  s_mov_b32 s31, 1843200
  s_mov_b32 exec_hi, 255
  buffer_load_dwordx4 v165, s[16:19], s31 offen lds
  s_mov_b32 exec_hi, -1
  v_mfma_f32_32x32x16_bf16 v[64:79], v[120:123], v[96:99], v[64:79]
  s_waitcnt vmcnt(10) lgkmcnt(0)
  s_barrier
  v_mfma_f32_32x32x16_bf16 v[0:15], v[132:135], v[124:127], v[0:15]
  ds_read_b128 v[96:99], v188 offset:0
  ds_read_b64_tr_b16 v[104:105], v168 offset:24832
  ds_read_b64_tr_b16 v[106:107], v168 offset:25472
  ds_read_b64_tr_b16 v[108:109], v168 offset:24960
  v_mfma_f32_32x32x16_bf16 v[16:31], v[136:139], v[124:127], v[16:31]
  ds_read_b64_tr_b16 v[110:111], v168 offset:25600
  ds_read_b64_tr_b16 v[112:113], v168 offset:25088
  ds_read_b64_tr_b16 v[114:115], v168 offset:25728
  ds_read_b64_tr_b16 v[116:117], v168 offset:25216
  v_mfma_f32_32x32x16_bf16 v[32:47], v[140:143], v[124:127], v[32:47]
  ds_read_b64_tr_b16 v[118:119], v168 offset:25856
  ds_read_b64_tr_b16 v[120:121], v168 offset:25344
  ds_read_b64_tr_b16 v[122:123], v168 offset:25984
  v_cmp_eq_u32 vcc, 0, v207
  v_mov_b32 v192, 0x40000000
  s_lshl_b32 s26, s72, 7
  s_add_u32 s26, s26, 16384
  s_cmp_eq_u32 s20, 0
  s_cselect_b32 s26, s26, 0x40000000
  v_mov_b32 v193, s82
  v_cndmask_b32 v192, v192, 0, vcc
  buffer_store_dword v193, v192, s[64:67], s26 offen sc1
  v_mfma_f32_32x32x16_bf16 v[48:63], v[144:147], v[124:127], v[48:63]
  s_add_u32 m0, s24, 8192
  s_movk_i32 s30, 1024
  buffer_load_dwordx4 v184, s[8:11], s30 offen lds
  v_mfma_f32_32x32x16_bf16 v[64:79], v[148:151], v[124:127], v[64:79]
  s_add_u32 m0, s24, 9216
  s_movk_i32 s30, 1024
  buffer_load_dwordx4 v185, s[8:11], s30 offen lds
  s_waitcnt lgkmcnt(0)
  v_mfma_f32_32x32x16_bf16 v[0:15], v[104:107], v[96:99], v[0:15]
  ds_read_b128 v[124:127], v189 offset:0
  ds_read_b64_tr_b16 v[132:133], v168 offset:27392
  ds_read_b64_tr_b16 v[134:135], v168 offset:28032
  ds_read_b64_tr_b16 v[136:137], v168 offset:27520
  v_mfma_f32_32x32x16_bf16 v[16:31], v[108:111], v[96:99], v[16:31]
  ds_read_b64_tr_b16 v[138:139], v168 offset:28160
  ds_read_b64_tr_b16 v[140:141], v168 offset:27648
  ds_read_b64_tr_b16 v[142:143], v168 offset:28288
  ds_read_b64_tr_b16 v[144:145], v168 offset:27776
  v_mfma_f32_32x32x16_bf16 v[32:47], v[112:115], v[96:99], v[32:47]
  ds_read_b64_tr_b16 v[146:147], v168 offset:28416
  ds_read_b64_tr_b16 v[148:149], v168 offset:27904
  ds_read_b64_tr_b16 v[150:151], v168 offset:28544
  s_add_u32 m0, s25, 12416
  s_mov_b32 s31, 1966080
  s_mov_b32 exec_hi, 255
  buffer_load_dwordx4 v165, s[12:15], s31 offen lds
  s_mov_b32 exec_hi, -1
  v_mfma_f32_32x32x16_bf16 v[48:63], v[116:119], v[96:99], v[48:63]
  s_add_u32 m0, s25, 17664
  s_mov_b32 s31, 1966080
  s_mov_b32 exec_hi, 255
  buffer_load_dwordx4 v165, s[16:19], s31 offen lds
  s_mov_b32 exec_hi, -1
  v_mfma_f32_32x32x16_bf16 v[64:79], v[120:123], v[96:99], v[64:79]
  s_waitcnt vmcnt(13) lgkmcnt(0)
  s_barrier
  v_mfma_f32_32x32x16_bf16 v[0:15], v[132:135], v[124:127], v[0:15]
  ds_read_b128 v[96:99], v190 offset:0
  ds_read_b64_tr_b16 v[104:105], v168 offset:37248
  ds_read_b64_tr_b16 v[106:107], v168 offset:37888
  ds_read_b64_tr_b16 v[108:109], v168 offset:37376
  v_mfma_f32_32x32x16_bf16 v[16:31], v[136:139], v[124:127], v[16:31]
  ds_read_b64_tr_b16 v[110:111], v168 offset:38016
  ds_read_b64_tr_b16 v[112:113], v168 offset:37504
  ds_read_b64_tr_b16 v[114:115], v168 offset:38144
  ds_read_b64_tr_b16 v[116:117], v168 offset:37632
  v_mfma_f32_32x32x16_bf16 v[32:47], v[140:143], v[124:127], v[32:47]
  ds_read_b64_tr_b16 v[118:119], v168 offset:38272
  ds_read_b64_tr_b16 v[120:121], v168 offset:37760
  ds_read_b64_tr_b16 v[122:123], v168 offset:38400
  s_add_u32 m0, s24, 10240
  s_movk_i32 s30, 1024
  buffer_load_dwordx4 v186, s[8:11], s30 offen lds
  v_mfma_f32_32x32x16_bf16 v[48:63], v[144:147], v[124:127], v[48:63]
  s_add_u32 m0, s24, 11264
  s_movk_i32 s30, 1024
  buffer_load_dwordx4 v187, s[8:11], s30 offen lds
  v_mfma_f32_32x32x16_bf16 v[64:79], v[148:151], v[124:127], v[64:79]
  s_waitcnt lgkmcnt(0)
  v_mfma_f32_32x32x16_bf16 v[0:15], v[104:107], v[96:99], v[0:15]
  ds_read_b128 v[124:127], v191 offset:0
  ds_read_b64_tr_b16 v[132:133], v168 offset:39808
  ds_read_b64_tr_b16 v[134:135], v168 offset:40448
  ds_read_b64_tr_b16 v[136:137], v168 offset:39936
  v_mfma_f32_32x32x16_bf16 v[16:31], v[108:111], v[96:99], v[16:31]
  ds_read_b64_tr_b16 v[138:139], v168 offset:40576
  ds_read_b64_tr_b16 v[140:141], v168 offset:40064
  ds_read_b64_tr_b16 v[142:143], v168 offset:40704
  ds_read_b64_tr_b16 v[144:145], v168 offset:40192
  v_mfma_f32_32x32x16_bf16 v[32:47], v[112:115], v[96:99], v[32:47]
  ds_read_b64_tr_b16 v[146:147], v168 offset:40832
  ds_read_b64_tr_b16 v[148:149], v168 offset:40320
  ds_read_b64_tr_b16 v[150:151], v168 offset:40960
  s_add_u32 m0, s25, 24832
  s_mov_b32 s31, 2088960
  s_mov_b32 exec_hi, 255
  buffer_load_dwordx4 v165, s[12:15], s31 offen lds
  s_mov_b32 exec_hi, -1
  v_mfma_f32_32x32x16_bf16 v[48:63], v[116:119], v[96:99], v[48:63]
  s_add_u32 m0, s25, 30080
  s_mov_b32 s31, 2088960
  s_mov_b32 exec_hi, 255
  buffer_load_dwordx4 v165, s[16:19], s31 offen lds
  s_mov_b32 exec_hi, -1
  v_mfma_f32_32x32x16_bf16 v[64:79], v[120:123], v[96:99], v[64:79]
  s_waitcnt vmcnt(11) lgkmcnt(0)
  s_barrier
  v_mfma_f32_32x32x16_bf16 v[0:15], v[132:135], v[124:127], v[0:15]
  ds_read_b128 v[96:99], v188 offset:4096
  ds_read_b64_tr_b16 v[104:105], v168 offset:49664
  ds_read_b64_tr_b16 v[106:107], v168 offset:50304
  ds_read_b64_tr_b16 v[108:109], v168 offset:49792
  v_mfma_f32_32x32x16_bf16 v[16:31], v[136:139], v[124:127], v[16:31]
  ds_read_b64_tr_b16 v[110:111], v168 offset:50432
  ds_read_b64_tr_b16 v[112:113], v168 offset:49920
  ds_read_b64_tr_b16 v[114:115], v168 offset:50560
  ds_read_b64_tr_b16 v[116:117], v168 offset:50048
  v_mfma_f32_32x32x16_bf16 v[32:47], v[140:143], v[124:127], v[32:47]
  ds_read_b64_tr_b16 v[118:119], v168 offset:50688
  ds_read_b64_tr_b16 v[120:121], v168 offset:50176
  ds_read_b64_tr_b16 v[122:123], v168 offset:50816
  s_add_u32 m0, s24, 0
  s_movk_i32 s30, 1152
  buffer_load_dwordx4 v184, s[8:11], s30 offen lds
  v_mfma_f32_32x32x16_bf16 v[48:63], v[144:147], v[124:127], v[48:63]
  s_add_u32 m0, s24, 1024
  s_movk_i32 s30, 1152
  buffer_load_dwordx4 v185, s[8:11], s30 offen lds
  v_mfma_f32_32x32x16_bf16 v[64:79], v[148:151], v[124:127], v[64:79]
  s_waitcnt lgkmcnt(0)
  v_mfma_f32_32x32x16_bf16 v[0:15], v[104:107], v[96:99], v[0:15]
  ds_read_b128 v[124:127], v189 offset:4096
  ds_read_b64_tr_b16 v[132:133], v168 offset:52224
  ds_read_b64_tr_b16 v[134:135], v168 offset:52864
  ds_read_b64_tr_b16 v[136:137], v168 offset:52352
  v_mfma_f32_32x32x16_bf16 v[16:31], v[108:111], v[96:99], v[16:31]
  ds_read_b64_tr_b16 v[138:139], v168 offset:52992
  ds_read_b64_tr_b16 v[140:141], v168 offset:52480
  ds_read_b64_tr_b16 v[142:143], v168 offset:53120
  ds_read_b64_tr_b16 v[144:145], v168 offset:52608
  v_mfma_f32_32x32x16_bf16 v[32:47], v[112:115], v[96:99], v[32:47]
  ds_read_b64_tr_b16 v[146:147], v168 offset:53248
  ds_read_b64_tr_b16 v[148:149], v168 offset:52736
  ds_read_b64_tr_b16 v[150:151], v168 offset:53376
  s_add_u32 m0, s25, 37248
  s_mov_b32 s31, 2211840
  s_mov_b32 exec_hi, 255
  buffer_load_dwordx4 v165, s[12:15], s31 offen lds
  s_mov_b32 exec_hi, -1
  v_mfma_f32_32x32x16_bf16 v[48:63], v[116:119], v[96:99], v[48:63]
  s_add_u32 m0, s25, 42496
  s_mov_b32 s31, 2211840
  s_mov_b32 exec_hi, 255
  buffer_load_dwordx4 v165, s[16:19], s31 offen lds
  s_mov_b32 exec_hi, -1
  v_mfma_f32_32x32x16_bf16 v[64:79], v[120:123], v[96:99], v[64:79]
  s_waitcnt vmcnt(13) lgkmcnt(0)
  s_barrier
  v_mfma_f32_32x32x16_bf16 v[0:15], v[132:135], v[124:127], v[0:15]
  ds_read_b128 v[96:99], v190 offset:4096
  ds_read_b64_tr_b16 v[104:105], v168 offset:0
  ds_read_b64_tr_b16 v[106:107], v168 offset:640
  ds_read_b64_tr_b16 v[108:109], v168 offset:128
  v_mfma_f32_32x32x16_bf16 v[16:31], v[136:139], v[124:127], v[16:31]
  ds_read_b64_tr_b16 v[110:111], v168 offset:768
  ds_read_b64_tr_b16 v[112:113], v168 offset:256
  ds_read_b64_tr_b16 v[114:115], v168 offset:896
  ds_read_b64_tr_b16 v[116:117], v168 offset:384
  v_mfma_f32_32x32x16_bf16 v[32:47], v[140:143], v[124:127], v[32:47]
  ds_read_b64_tr_b16 v[118:119], v168 offset:1024
  ds_read_b64_tr_b16 v[120:121], v168 offset:512
  ds_read_b64_tr_b16 v[122:123], v168 offset:1152
  s_cmp_lg_u32 s20, 0
  s_cbranch_scc1 FPQ_done
  v_and_b32 v192, 7, v207
  s_and_b32 s26, s72, 31
  v_lshl_add_u32 v192, v192, 5, s26
  s_and_b32 s26, s72, 0xe0
  v_add_u32 v193, s26, v207
  v_cmp_gt_u32 vcc, 32, v207
  s_nop 1
  v_cndmask_b32 v192, v192, v193, vcc

  v_lshlrev_b32 v192, 7, v192
  s_mov_b32 s26, 0x100000
  s_mov_b32 s83, 16384
FPQ_loop:
  buffer_load_dword v193, v192, s[64:67], s83 offen sc1
  s_sub_u32 s26, s26, 1
  s_cbranch_scc1 FPQ_done
  s_waitcnt vmcnt(0)
  v_cmp_ne_u32 vcc, s82, v193
  s_cbranch_vccz FPQ_done
  s_sleep 1
  s_branch FPQ_loop
FPQ_done:
  v_mfma_f32_32x32x16_bf16 v[48:63], v[144:147], v[124:127], v[48:63]
  s_add_u32 m0, s24, 2048
  s_movk_i32 s30, 1152
  buffer_load_dwordx4 v186, s[8:11], s30 offen lds
  v_mfma_f32_32x32x16_bf16 v[64:79], v[148:151], v[124:127], v[64:79]
  s_add_u32 m0, s24, 3072
  s_movk_i32 s30, 1152
  buffer_load_dwordx4 v187, s[8:11], s30 offen lds
  s_waitcnt lgkmcnt(0)
  v_mfma_f32_32x32x16_bf16 v[0:15], v[104:107], v[96:99], v[0:15]
  ds_read_b128 v[124:127], v191 offset:4096
  ds_read_b64_tr_b16 v[132:133], v168 offset:2560
  ds_read_b64_tr_b16 v[134:135], v168 offset:3200
  ds_read_b64_tr_b16 v[136:137], v168 offset:2688
  v_mfma_f32_32x32x16_bf16 v[16:31], v[108:111], v[96:99], v[16:31]
  ds_read_b64_tr_b16 v[138:139], v168 offset:3328
  ds_read_b64_tr_b16 v[140:141], v168 offset:2816
  ds_read_b64_tr_b16 v[142:143], v168 offset:3456
  ds_read_b64_tr_b16 v[144:145], v168 offset:2944
  v_mfma_f32_32x32x16_bf16 v[32:47], v[112:115], v[96:99], v[32:47]
  ds_read_b64_tr_b16 v[146:147], v168 offset:3584
  ds_read_b64_tr_b16 v[148:149], v168 offset:3072
  ds_read_b64_tr_b16 v[150:151], v168 offset:3712
  s_add_u32 m0, s25, 49664
  s_mov_b32 s31, 2334720
  s_mov_b32 exec_hi, 255
  buffer_load_dwordx4 v165, s[12:15], s31 offen lds
  s_mov_b32 exec_hi, -1
  v_mfma_f32_32x32x16_bf16 v[48:63], v[116:119], v[96:99], v[48:63]
  s_add_u32 m0, s25, 54912
  s_mov_b32 s31, 2334720
  s_mov_b32 exec_hi, 255
  buffer_load_dwordx4 v165, s[16:19], s31 offen lds
  s_mov_b32 exec_hi, -1
  v_mfma_f32_32x32x16_bf16 v[64:79], v[120:123], v[96:99], v[64:79]
  s_waitcnt vmcnt(10) lgkmcnt(0)
  s_barrier
  v_mfma_f32_32x32x16_bf16 v[0:15], v[132:135], v[124:127], v[0:15]
  ds_read_b128 v[96:99], v188 offset:8192
  ds_read_b64_tr_b16 v[104:105], v168 offset:12416
  ds_read_b64_tr_b16 v[106:107], v168 offset:13056
  ds_read_b64_tr_b16 v[108:109], v168 offset:12544
  v_mfma_f32_32x32x16_bf16 v[16:31], v[136:139], v[124:127], v[16:31]
  ds_read_b64_tr_b16 v[110:111], v168 offset:13184
  ds_read_b64_tr_b16 v[112:113], v168 offset:12672
  ds_read_b64_tr_b16 v[114:115], v168 offset:13312
  ds_read_b64_tr_b16 v[116:117], v168 offset:12800
  v_mfma_f32_32x32x16_bf16 v[32:47], v[140:143], v[124:127], v[32:47]
  ds_read_b64_tr_b16 v[118:119], v168 offset:13440
  ds_read_b64_tr_b16 v[120:121], v168 offset:12928
  ds_read_b64_tr_b16 v[122:123], v168 offset:13568
  v_and_b32 v192, 31, v207
  v_add_u32 v192, s59, v192
  v_lshlrev_b32 v192, 3, v192
  s_mul_i32 s33, s58, 6144
  s_add_u32 s33, s33, 114688
  s_add_u32 s34, s33, 3072
  v_lshl_add_u32 v193, s20, 6, v207
  v_cmp_gt_u32 vcc, 192, v193
  v_lshlrev_b32 v193, 2, v193
  v_mov_b32 v194, 0x40000000
  v_add_u32 v169, 160384, v193
  v_mov_b32 v195, 163456
  v_cndmask_b32 v193, v194, v193, vcc
  v_cndmask_b32 v169, v195, v169, vcc
  v_mfma_f32_32x32x16_bf16 v[48:63], v[144:147], v[124:127], v[48:63]
  buffer_load_dwordx2 v[208:209], v192, s[64:67], 0 offen offset:0 sc1
  v_mfma_f32_32x32x16_bf16 v[64:79], v[148:151], v[124:127], v[64:79]
  s_waitcnt lgkmcnt(0)
  v_mfma_f32_32x32x16_bf16 v[0:15], v[104:107], v[96:99], v[0:15]
  ds_read_b128 v[124:127], v189 offset:8192
  ds_read_b64_tr_b16 v[132:133], v168 offset:14976
  ds_read_b64_tr_b16 v[134:135], v168 offset:15616
  ds_read_b64_tr_b16 v[136:137], v168 offset:15104
  v_mfma_f32_32x32x16_bf16 v[16:31], v[108:111], v[96:99], v[16:31]
  ds_read_b64_tr_b16 v[138:139], v168 offset:15744
  ds_read_b64_tr_b16 v[140:141], v168 offset:15232
  ds_read_b64_tr_b16 v[142:143], v168 offset:15872
  ds_read_b64_tr_b16 v[144:145], v168 offset:15360
  v_mfma_f32_32x32x16_bf16 v[32:47], v[112:115], v[96:99], v[32:47]
  ds_read_b64_tr_b16 v[146:147], v168 offset:16000
  ds_read_b64_tr_b16 v[148:149], v168 offset:15488
  ds_read_b64_tr_b16 v[150:151], v168 offset:16128
  buffer_load_dword v216, v193, s[64:67], s33 offen offset:0 sc1
  buffer_load_dword v217, v193, s[64:67], s33 offen offset:768 sc1
  buffer_load_dword v218, v193, s[64:67], s33 offen offset:1536 sc1
  v_mfma_f32_32x32x16_bf16 v[48:63], v[116:119], v[96:99], v[48:63]
  buffer_load_dword v219, v193, s[64:67], s33 offen offset:2304 sc1
  buffer_load_dword v220, v193, s[64:67], s34 offen offset:0 sc1
  buffer_load_dword v221, v193, s[64:67], s34 offen offset:768 sc1
  v_mfma_f32_32x32x16_bf16 v[64:79], v[120:123], v[96:99], v[64:79]
  buffer_load_dword v222, v193, s[64:67], s34 offen offset:1536 sc1
  buffer_load_dword v223, v193, s[64:67], s34 offen offset:2304 sc1
  s_waitcnt vmcnt(17) lgkmcnt(0)
  s_barrier
  v_mfma_f32_32x32x16_bf16 v[0:15], v[132:135], v[124:127], v[0:15]
  ds_read_b128 v[96:99], v190 offset:8192
  ds_read_b64_tr_b16 v[104:105], v168 offset:24832
  ds_read_b64_tr_b16 v[106:107], v168 offset:25472
  ds_read_b64_tr_b16 v[108:109], v168 offset:24960
  v_mfma_f32_32x32x16_bf16 v[16:31], v[136:139], v[124:127], v[16:31]
  ds_read_b64_tr_b16 v[110:111], v168 offset:25600
  ds_read_b64_tr_b16 v[112:113], v168 offset:25088
  ds_read_b64_tr_b16 v[114:115], v168 offset:25728
  ds_read_b64_tr_b16 v[116:117], v168 offset:25216
  v_mfma_f32_32x32x16_bf16 v[32:47], v[140:143], v[124:127], v[32:47]
  ds_read_b64_tr_b16 v[118:119], v168 offset:25856
  ds_read_b64_tr_b16 v[120:121], v168 offset:25344
  ds_read_b64_tr_b16 v[122:123], v168 offset:25984
  v_mfma_f32_32x32x16_bf16 v[48:63], v[144:147], v[124:127], v[48:63]
  v_mfma_f32_32x32x16_bf16 v[64:79], v[148:151], v[124:127], v[64:79]
  s_waitcnt lgkmcnt(0)
  v_mfma_f32_32x32x16_bf16 v[0:15], v[104:107], v[96:99], v[0:15]
  ds_read_b128 v[124:127], v191 offset:8192
  ds_read_b64_tr_b16 v[132:133], v168 offset:27392
  ds_read_b64_tr_b16 v[134:135], v168 offset:28032
  ds_read_b64_tr_b16 v[136:137], v168 offset:27520
  v_mfma_f32_32x32x16_bf16 v[16:31], v[108:111], v[96:99], v[16:31]
  ds_read_b64_tr_b16 v[138:139], v168 offset:28160
  ds_read_b64_tr_b16 v[140:141], v168 offset:27648
  ds_read_b64_tr_b16 v[142:143], v168 offset:28288
  ds_read_b64_tr_b16 v[144:145], v168 offset:27776
  v_mfma_f32_32x32x16_bf16 v[32:47], v[112:115], v[96:99], v[32:47]
  ds_read_b64_tr_b16 v[146:147], v168 offset:28416
  ds_read_b64_tr_b16 v[148:149], v168 offset:27904
  ds_read_b64_tr_b16 v[150:151], v168 offset:28544
  v_mfma_f32_32x32x16_bf16 v[48:63], v[116:119], v[96:99], v[48:63]
  v_mfma_f32_32x32x16_bf16 v[64:79], v[120:123], v[96:99], v[64:79]
  s_waitcnt vmcnt(11) lgkmcnt(0)
  s_barrier
  v_mfma_f32_32x32x16_bf16 v[0:15], v[132:135], v[124:127], v[0:15]
  ds_read_b128 v[96:99], v188 offset:0
  ds_read_b64_tr_b16 v[104:105], v168 offset:37248
  ds_read_b64_tr_b16 v[106:107], v168 offset:37888
  ds_read_b64_tr_b16 v[108:109], v168 offset:37376
  v_mfma_f32_32x32x16_bf16 v[16:31], v[136:139], v[124:127], v[16:31]
  ds_read_b64_tr_b16 v[110:111], v168 offset:38016
  ds_read_b64_tr_b16 v[112:113], v168 offset:37504
  ds_read_b64_tr_b16 v[114:115], v168 offset:38144
  ds_read_b64_tr_b16 v[116:117], v168 offset:37632
  v_mfma_f32_32x32x16_bf16 v[32:47], v[140:143], v[124:127], v[32:47]
  ds_read_b64_tr_b16 v[118:119], v168 offset:38272
  ds_read_b64_tr_b16 v[120:121], v168 offset:37760
  ds_read_b64_tr_b16 v[122:123], v168 offset:38400
  v_mfma_f32_32x32x16_bf16 v[48:63], v[144:147], v[124:127], v[48:63]
  v_mfma_f32_32x32x16_bf16 v[64:79], v[148:151], v[124:127], v[64:79]
  s_waitcnt lgkmcnt(0)
  v_mfma_f32_32x32x16_bf16 v[0:15], v[104:107], v[96:99], v[0:15]
  ds_read_b128 v[124:127], v189 offset:0
  ds_read_b64_tr_b16 v[132:133], v168 offset:39808
  ds_read_b64_tr_b16 v[134:135], v168 offset:40448
  ds_read_b64_tr_b16 v[136:137], v168 offset:39936
  v_mfma_f32_32x32x16_bf16 v[16:31], v[108:111], v[96:99], v[16:31]
  ds_read_b64_tr_b16 v[138:139], v168 offset:40576
  ds_read_b64_tr_b16 v[140:141], v168 offset:40064
  ds_read_b64_tr_b16 v[142:143], v168 offset:40704
  ds_read_b64_tr_b16 v[144:145], v168 offset:40192
  v_mfma_f32_32x32x16_bf16 v[32:47], v[112:115], v[96:99], v[32:47]
  ds_read_b64_tr_b16 v[146:147], v168 offset:40832
  ds_read_b64_tr_b16 v[148:149], v168 offset:40320
  ds_read_b64_tr_b16 v[150:151], v168 offset:40960
  v_mfma_f32_32x32x16_bf16 v[48:63], v[116:119], v[96:99], v[48:63]
  v_mfma_f32_32x32x16_bf16 v[64:79], v[120:123], v[96:99], v[64:79]
  s_waitcnt vmcnt(0) lgkmcnt(0)
  s_barrier
  v_mfma_f32_32x32x16_bf16 v[0:15], v[132:135], v[124:127], v[0:15]
  ds_read_b128 v[96:99], v190 offset:0
  ds_read_b64_tr_b16 v[104:105], v168 offset:49664
  ds_read_b64_tr_b16 v[106:107], v168 offset:50304
  ds_read_b64_tr_b16 v[108:109], v168 offset:49792
  v_mfma_f32_32x32x16_bf16 v[16:31], v[136:139], v[124:127], v[16:31]
  ds_read_b64_tr_b16 v[110:111], v168 offset:50432
  ds_read_b64_tr_b16 v[112:113], v168 offset:49920
  ds_read_b64_tr_b16 v[114:115], v168 offset:50560
  ds_read_b64_tr_b16 v[116:117], v168 offset:50048
  v_mfma_f32_32x32x16_bf16 v[32:47], v[140:143], v[124:127], v[32:47]
  ds_read_b64_tr_b16 v[118:119], v168 offset:50688
  ds_read_b64_tr_b16 v[120:121], v168 offset:50176
  ds_read_b64_tr_b16 v[122:123], v168 offset:50816
  v_add_f32 v216, v216, v220
  v_add_f32 v217, v217, v221
  v_add_f32 v218, v218, v222
  v_add_f32 v219, v219, v223
  v_add_f32 v216, v216, v218
  v_add_f32 v217, v217, v219
  v_add_f32 v216, v216, v217
  ds_write_b32 v169, v216
  v_mfma_f32_32x32x16_bf16 v[48:63], v[144:147], v[124:127], v[48:63]
  v_mfma_f32_32x32x16_bf16 v[64:79], v[148:151], v[124:127], v[64:79]
  s_waitcnt lgkmcnt(0)
  v_mfma_f32_32x32x16_bf16 v[0:15], v[104:107], v[96:99], v[0:15]
  ds_read_b128 v[124:127], v191 offset:0
  ds_read_b64_tr_b16 v[132:133], v168 offset:52224
  ds_read_b64_tr_b16 v[134:135], v168 offset:52864
  ds_read_b64_tr_b16 v[136:137], v168 offset:52352
  v_mfma_f32_32x32x16_bf16 v[16:31], v[108:111], v[96:99], v[16:31]
  ds_read_b64_tr_b16 v[138:139], v168 offset:52992
  ds_read_b64_tr_b16 v[140:141], v168 offset:52480
  ds_read_b64_tr_b16 v[142:143], v168 offset:53120
  ds_read_b64_tr_b16 v[144:145], v168 offset:52608
  v_mfma_f32_32x32x16_bf16 v[32:47], v[112:115], v[96:99], v[32:47]
  ds_read_b64_tr_b16 v[146:147], v168 offset:53248
  ds_read_b64_tr_b16 v[148:149], v168 offset:52736
  ds_read_b64_tr_b16 v[150:151], v168 offset:53376
  v_mfma_f32_32x32x16_bf16 v[48:63], v[116:119], v[96:99], v[48:63]
  v_mfma_f32_32x32x16_bf16 v[64:79], v[120:123], v[96:99], v[64:79]
  s_waitcnt lgkmcnt(0)
  v_mfma_f32_32x32x16_bf16 v[0:15], v[132:135], v[124:127], v[0:15]
  v_mfma_f32_32x32x16_bf16 v[16:31], v[136:139], v[124:127], v[16:31]
  v_mfma_f32_32x32x16_bf16 v[32:47], v[140:143], v[124:127], v[32:47]
  v_mfma_f32_32x32x16_bf16 v[48:63], v[144:147], v[124:127], v[48:63]
  v_mfma_f32_32x32x16_bf16 v[64:79], v[148:151], v[124:127], v[64:79]
  v_and_b32 v170, 31, v207
  v_lshrrev_b32 v171, 5, v207
  v_lshlrev_b32 v172, 4, v171
  s_mul_i32 s26, s56, 0
  s_add_u32 s26, s26, 160384
  v_add_u32 v172, s26, v172
  v_add_u32 v170, s59, v170
  s_waitcnt lgkmcnt(0)
  s_barrier

  v_mul_f32 v209, s23, v209
  ds_read_b128 v[96:99], v172 offset:0
  ds_read_b128 v[100:103], v172 offset:32
  ds_read_b128 v[104:107], v172 offset:64
  ds_read_b128 v[108:111], v172 offset:96
  ds_read_b128 v[112:115], v172 offset:128
  ds_read_b128 v[116:119], v172 offset:160
  ds_read_b128 v[120:123], v172 offset:192
  ds_read_b128 v[124:127], v172 offset:224
  ds_read_b128 v[128:131], v172 offset:256
  ds_read_b128 v[132:135], v172 offset:288
  ds_read_b128 v[136:139], v172 offset:320
  ds_read_b128 v[140:143], v172 offset:352
  s_waitcnt lgkmcnt(11)
  v_pk_fma_f32 v[0:1], v[96:97], v[208:209], v[0:1] op_sel_hi:[1,0,1]
  v_pk_fma_f32 v[2:3], v[98:99], v[208:209], v[2:3] op_sel_hi:[1,0,1]
  v_pk_mul_f32 v[0:1], v[0:1], v[208:209] op_sel:[0,1] op_sel_hi:[1,1]
  v_pk_mul_f32 v[2:3], v[2:3], v[208:209] op_sel:[0,1] op_sel_hi:[1,1]
  s_waitcnt lgkmcnt(10)
  v_pk_fma_f32 v[4:5], v[100:101], v[208:209], v[4:5] op_sel_hi:[1,0,1]
  v_pk_fma_f32 v[6:7], v[102:103], v[208:209], v[6:7] op_sel_hi:[1,0,1]
  v_pk_mul_f32 v[4:5], v[4:5], v[208:209] op_sel:[0,1] op_sel_hi:[1,1]
  v_pk_mul_f32 v[6:7], v[6:7], v[208:209] op_sel:[0,1] op_sel_hi:[1,1]
  s_waitcnt lgkmcnt(9)
  v_pk_fma_f32 v[8:9], v[104:105], v[208:209], v[8:9] op_sel_hi:[1,0,1]
  v_pk_fma_f32 v[10:11], v[106:107], v[208:209], v[10:11] op_sel_hi:[1,0,1]
  v_pk_mul_f32 v[8:9], v[8:9], v[208:209] op_sel:[0,1] op_sel_hi:[1,1]
  v_pk_mul_f32 v[10:11], v[10:11], v[208:209] op_sel:[0,1] op_sel_hi:[1,1]
  s_waitcnt lgkmcnt(8)
  v_pk_fma_f32 v[12:13], v[108:109], v[208:209], v[12:13] op_sel_hi:[1,0,1]
  v_pk_fma_f32 v[14:15], v[110:111], v[208:209], v[14:15] op_sel_hi:[1,0,1]
  v_pk_mul_f32 v[12:13], v[12:13], v[208:209] op_sel:[0,1] op_sel_hi:[1,1]
  v_pk_mul_f32 v[14:15], v[14:15], v[208:209] op_sel:[0,1] op_sel_hi:[1,1]
  s_waitcnt lgkmcnt(7)
  v_pk_fma_f32 v[16:17], v[112:113], v[208:209], v[16:17] op_sel_hi:[1,0,1]
  v_pk_fma_f32 v[18:19], v[114:115], v[208:209], v[18:19] op_sel_hi:[1,0,1]
  v_pk_mul_f32 v[16:17], v[16:17], v[208:209] op_sel:[0,1] op_sel_hi:[1,1]
  v_pk_mul_f32 v[18:19], v[18:19], v[208:209] op_sel:[0,1] op_sel_hi:[1,1]
  s_waitcnt lgkmcnt(6)
  v_pk_fma_f32 v[20:21], v[116:117], v[208:209], v[20:21] op_sel_hi:[1,0,1]
  v_pk_fma_f32 v[22:23], v[118:119], v[208:209], v[22:23] op_sel_hi:[1,0,1]
  v_pk_mul_f32 v[20:21], v[20:21], v[208:209] op_sel:[0,1] op_sel_hi:[1,1]
  v_pk_mul_f32 v[22:23], v[22:23], v[208:209] op_sel:[0,1] op_sel_hi:[1,1]
  s_waitcnt lgkmcnt(5)
  v_pk_fma_f32 v[24:25], v[120:121], v[208:209], v[24:25] op_sel_hi:[1,0,1]
  v_pk_fma_f32 v[26:27], v[122:123], v[208:209], v[26:27] op_sel_hi:[1,0,1]
  v_pk_mul_f32 v[24:25], v[24:25], v[208:209] op_sel:[0,1] op_sel_hi:[1,1]
  v_pk_mul_f32 v[26:27], v[26:27], v[208:209] op_sel:[0,1] op_sel_hi:[1,1]
  s_waitcnt lgkmcnt(4)
  v_pk_fma_f32 v[28:29], v[124:125], v[208:209], v[28:29] op_sel_hi:[1,0,1]
  v_pk_fma_f32 v[30:31], v[126:127], v[208:209], v[30:31] op_sel_hi:[1,0,1]
  v_pk_mul_f32 v[28:29], v[28:29], v[208:209] op_sel:[0,1] op_sel_hi:[1,1]
  v_pk_mul_f32 v[30:31], v[30:31], v[208:209] op_sel:[0,1] op_sel_hi:[1,1]
  s_waitcnt lgkmcnt(3)
  v_pk_fma_f32 v[32:33], v[128:129], v[208:209], v[32:33] op_sel_hi:[1,0,1]
  v_pk_fma_f32 v[34:35], v[130:131], v[208:209], v[34:35] op_sel_hi:[1,0,1]
  v_pk_mul_f32 v[32:33], v[32:33], v[208:209] op_sel:[0,1] op_sel_hi:[1,1]
  v_pk_mul_f32 v[34:35], v[34:35], v[208:209] op_sel:[0,1] op_sel_hi:[1,1]
  s_waitcnt lgkmcnt(2)
  v_pk_fma_f32 v[36:37], v[132:133], v[208:209], v[36:37] op_sel_hi:[1,0,1]
  v_pk_fma_f32 v[38:39], v[134:135], v[208:209], v[38:39] op_sel_hi:[1,0,1]
  v_pk_mul_f32 v[36:37], v[36:37], v[208:209] op_sel:[0,1] op_sel_hi:[1,1]
  v_pk_mul_f32 v[38:39], v[38:39], v[208:209] op_sel:[0,1] op_sel_hi:[1,1]
  s_waitcnt lgkmcnt(1)
  v_pk_fma_f32 v[40:41], v[136:137], v[208:209], v[40:41] op_sel_hi:[1,0,1]
  v_pk_fma_f32 v[42:43], v[138:139], v[208:209], v[42:43] op_sel_hi:[1,0,1]
  v_pk_mul_f32 v[40:41], v[40:41], v[208:209] op_sel:[0,1] op_sel_hi:[1,1]
  v_pk_mul_f32 v[42:43], v[42:43], v[208:209] op_sel:[0,1] op_sel_hi:[1,1]
  s_waitcnt lgkmcnt(0)
  v_pk_fma_f32 v[44:45], v[140:141], v[208:209], v[44:45] op_sel_hi:[1,0,1]
  v_pk_fma_f32 v[46:47], v[142:143], v[208:209], v[46:47] op_sel_hi:[1,0,1]
  v_pk_mul_f32 v[44:45], v[44:45], v[208:209] op_sel:[0,1] op_sel_hi:[1,1]
  v_pk_mul_f32 v[46:47], v[46:47], v[208:209] op_sel:[0,1] op_sel_hi:[1,1]
  ds_read_b128 v[96:99], v172 offset:384
  ds_read_b128 v[100:103], v172 offset:416
  ds_read_b128 v[104:107], v172 offset:448
  ds_read_b128 v[108:111], v172 offset:480
  ds_read_b128 v[112:115], v172 offset:512
  ds_read_b128 v[116:119], v172 offset:544
  ds_read_b128 v[120:123], v172 offset:576
  ds_read_b128 v[124:127], v172 offset:608
  s_waitcnt lgkmcnt(7)
  v_pk_fma_f32 v[48:49], v[96:97], v[208:209], v[48:49] op_sel_hi:[1,0,1]
  v_pk_fma_f32 v[50:51], v[98:99], v[208:209], v[50:51] op_sel_hi:[1,0,1]
  v_pk_mul_f32 v[48:49], v[48:49], v[208:209] op_sel:[0,1] op_sel_hi:[1,1]
  v_pk_mul_f32 v[50:51], v[50:51], v[208:209] op_sel:[0,1] op_sel_hi:[1,1]
  s_waitcnt lgkmcnt(6)
  v_pk_fma_f32 v[52:53], v[100:101], v[208:209], v[52:53] op_sel_hi:[1,0,1]
  v_pk_fma_f32 v[54:55], v[102:103], v[208:209], v[54:55] op_sel_hi:[1,0,1]
  v_pk_mul_f32 v[52:53], v[52:53], v[208:209] op_sel:[0,1] op_sel_hi:[1,1]
  v_pk_mul_f32 v[54:55], v[54:55], v[208:209] op_sel:[0,1] op_sel_hi:[1,1]
  s_waitcnt lgkmcnt(5)
  v_pk_fma_f32 v[56:57], v[104:105], v[208:209], v[56:57] op_sel_hi:[1,0,1]
  v_pk_fma_f32 v[58:59], v[106:107], v[208:209], v[58:59] op_sel_hi:[1,0,1]
  v_pk_mul_f32 v[56:57], v[56:57], v[208:209] op_sel:[0,1] op_sel_hi:[1,1]
  v_pk_mul_f32 v[58:59], v[58:59], v[208:209] op_sel:[0,1] op_sel_hi:[1,1]
  s_waitcnt lgkmcnt(4)
  v_pk_fma_f32 v[60:61], v[108:109], v[208:209], v[60:61] op_sel_hi:[1,0,1]
  v_pk_fma_f32 v[62:63], v[110:111], v[208:209], v[62:63] op_sel_hi:[1,0,1]
  v_pk_mul_f32 v[60:61], v[60:61], v[208:209] op_sel:[0,1] op_sel_hi:[1,1]
  v_pk_mul_f32 v[62:63], v[62:63], v[208:209] op_sel:[0,1] op_sel_hi:[1,1]
  s_waitcnt lgkmcnt(3)
  v_pk_fma_f32 v[64:65], v[112:113], v[208:209], v[64:65] op_sel_hi:[1,0,1]
  v_pk_fma_f32 v[66:67], v[114:115], v[208:209], v[66:67] op_sel_hi:[1,0,1]
  v_pk_mul_f32 v[64:65], v[64:65], v[208:209] op_sel:[0,1] op_sel_hi:[1,1]
  v_pk_mul_f32 v[66:67], v[66:67], v[208:209] op_sel:[0,1] op_sel_hi:[1,1]
  s_waitcnt lgkmcnt(2)
  v_pk_fma_f32 v[68:69], v[116:117], v[208:209], v[68:69] op_sel_hi:[1,0,1]
  v_pk_fma_f32 v[70:71], v[118:119], v[208:209], v[70:71] op_sel_hi:[1,0,1]
  v_pk_mul_f32 v[68:69], v[68:69], v[208:209] op_sel:[0,1] op_sel_hi:[1,1]
  v_pk_mul_f32 v[70:71], v[70:71], v[208:209] op_sel:[0,1] op_sel_hi:[1,1]
  s_waitcnt lgkmcnt(1)
  v_pk_fma_f32 v[72:73], v[120:121], v[208:209], v[72:73] op_sel_hi:[1,0,1]
  v_pk_fma_f32 v[74:75], v[122:123], v[208:209], v[74:75] op_sel_hi:[1,0,1]
  v_pk_mul_f32 v[72:73], v[72:73], v[208:209] op_sel:[0,1] op_sel_hi:[1,1]
  v_pk_mul_f32 v[74:75], v[74:75], v[208:209] op_sel:[0,1] op_sel_hi:[1,1]
  s_waitcnt lgkmcnt(0)
  v_pk_fma_f32 v[76:77], v[124:125], v[208:209], v[76:77] op_sel_hi:[1,0,1]
  v_pk_fma_f32 v[78:79], v[126:127], v[208:209], v[78:79] op_sel_hi:[1,0,1]
  v_pk_mul_f32 v[76:77], v[76:77], v[208:209] op_sel:[0,1] op_sel_hi:[1,1]
  v_pk_mul_f32 v[78:79], v[78:79], v[208:209] op_sel:[0,1] op_sel_hi:[1,1]
  v_and_b32 v170, 31, v207
  v_mul_u32_u24 v170, 48, v170
  s_mul_i32 s26, s20, 12288
  s_movk_i32 s33, 6144
  v_mad_u32_u24 v170, v171, s33, v170
  v_add_u32 v170, s26, v170
  v_lshl_add_u32 v171, v207, 4, s26
  s_mul_i32 s33, s27, 98304
  s_mul_i32 s26, s59, 48
  s_add_u32 s33, s33, s26
  v_lshlrev_b32 v173, 4, v207
  v_add_u32 v175, 98816, v173
  v_add_u32 v174, 1024, v173
  v_add_u32 v176, 97792, v173
  v_cmp_gt_u32 vcc, 32, v207
  s_nop 1
  v_cndmask_b32 v174, v176, v174, vcc
  v_cvt_pk_bf16_f32 v96, v0, v1
  v_cvt_pk_bf16_f32 v97, v2, v3
  v_cvt_pk_bf16_f32 v98, v4, v5
  v_cvt_pk_bf16_f32 v99, v6, v7
  v_cvt_pk_bf16_f32 v100, v8, v9
  v_cvt_pk_bf16_f32 v101, v10, v11
  v_cvt_pk_bf16_f32 v102, v12, v13
  v_cvt_pk_bf16_f32 v103, v14, v15
  v_cvt_pk_bf16_f32 v104, v16, v17
  v_cvt_pk_bf16_f32 v105, v18, v19
  v_mov_b32 v106, s29
  v_mov_b32 v107, s29
  ds_write_b128 v170, v[96:99] offset:0
  ds_write_b128 v170, v[100:103] offset:16
  ds_write_b128 v170, v[104:107] offset:32
  v_cvt_pk_bf16_f32 v108, v20, v21
  v_cvt_pk_bf16_f32 v109, v22, v23
  v_cvt_pk_bf16_f32 v110, v24, v25
  v_cvt_pk_bf16_f32 v111, v26, v27
  v_cvt_pk_bf16_f32 v112, v28, v29
  v_cvt_pk_bf16_f32 v113, v30, v31
  v_cvt_pk_bf16_f32 v114, v32, v33
  v_cvt_pk_bf16_f32 v115, v34, v35
  v_cvt_pk_bf16_f32 v116, v36, v37
  v_cvt_pk_bf16_f32 v117, v38, v39
  v_mov_b32 v118, s29
  v_mov_b32 v119, s29
  ds_write_b128 v170, v[108:111] offset:1536
  ds_write_b128 v170, v[112:115] offset:1552
  ds_write_b128 v170, v[116:119] offset:1568
  v_cvt_pk_bf16_f32 v120, v40, v41
  v_cvt_pk_bf16_f32 v121, v42, v43
  v_cvt_pk_bf16_f32 v122, v44, v45
  v_cvt_pk_bf16_f32 v123, v46, v47
  v_cvt_pk_bf16_f32 v124, v48, v49
  v_cvt_pk_bf16_f32 v125, v50, v51
  v_cvt_pk_bf16_f32 v126, v52, v53
  v_cvt_pk_bf16_f32 v127, v54, v55
  v_cvt_pk_bf16_f32 v128, v56, v57
  v_cvt_pk_bf16_f32 v129, v58, v59
  v_mov_b32 v130, s29
  v_mov_b32 v131, s29
  ds_write_b128 v170, v[120:123] offset:3072
  ds_write_b128 v170, v[124:127] offset:3088
  ds_write_b128 v170, v[128:131] offset:3104
  v_cvt_pk_bf16_f32 v132, v60, v61
  v_cvt_pk_bf16_f32 v133, v62, v63
  v_cvt_pk_bf16_f32 v134, v64, v65
  v_cvt_pk_bf16_f32 v135, v66, v67
  v_cvt_pk_bf16_f32 v136, v68, v69
  v_cvt_pk_bf16_f32 v137, v70, v71
  v_cvt_pk_bf16_f32 v138, v72, v73
  v_cvt_pk_bf16_f32 v139, v74, v75
  v_cvt_pk_bf16_f32 v140, v76, v77
  v_cvt_pk_bf16_f32 v141, v78, v79
  v_mov_b32 v142, s29
  v_mov_b32 v143, s29
  ds_write_b128 v170, v[132:135] offset:4608
  ds_write_b128 v170, v[136:139] offset:4624
  ds_write_b128 v170, v[140:143] offset:4640
  s_waitcnt lgkmcnt(0)
  ds_read_b128 v[0:3], v171 offset:0
  ds_read_b128 v[4:7], v171 offset:1024
  ds_read_b128 v[8:11], v171 offset:2048
  ds_read_b128 v[12:15], v171 offset:3072
  ds_read_b128 v[16:19], v171 offset:4096
  ds_read_b128 v[20:23], v171 offset:5120
  ds_read_b128 v[24:27], v171 offset:6144
  ds_read_b128 v[28:31], v171 offset:7168
  ds_read_b128 v[32:35], v171 offset:8192
  ds_read_b128 v[36:39], v171 offset:9216
  ds_read_b128 v[40:43], v171 offset:10240
  ds_read_b128 v[44:47], v171 offset:11264
  s_waitcnt lgkmcnt(11)
  buffer_store_dwordx4 v[0:3], v173, s[4:7], s33 offen sc1
  s_waitcnt lgkmcnt(10)
  buffer_store_dwordx4 v[4:7], v174, s[4:7], s33 offen sc1
  s_waitcnt lgkmcnt(9)
  buffer_store_dwordx4 v[8:11], v175, s[4:7], s33 offen sc1
  s_add_u32 s33, s33, 196608
  s_waitcnt lgkmcnt(8)
  buffer_store_dwordx4 v[12:15], v173, s[4:7], s33 offen sc1
  s_waitcnt lgkmcnt(7)
  buffer_store_dwordx4 v[16:19], v174, s[4:7], s33 offen sc1
  s_waitcnt lgkmcnt(6)
  buffer_store_dwordx4 v[20:23], v175, s[4:7], s33 offen sc1
  s_add_u32 s33, s33, 196608
  s_waitcnt lgkmcnt(5)
  buffer_store_dwordx4 v[24:27], v173, s[4:7], s33 offen sc1
  s_waitcnt lgkmcnt(4)
  buffer_store_dwordx4 v[28:31], v174, s[4:7], s33 offen sc1
  s_waitcnt lgkmcnt(3)
  buffer_store_dwordx4 v[32:35], v175, s[4:7], s33 offen sc1
  s_add_u32 s33, s33, 196608
  s_waitcnt lgkmcnt(2)
  buffer_store_dwordx4 v[36:39], v173, s[4:7], s33 offen sc1
  s_waitcnt lgkmcnt(1)
  buffer_store_dwordx4 v[40:43], v174, s[4:7], s33 offen sc1
  s_waitcnt lgkmcnt(0)
  buffer_store_dwordx4 v[44:47], v175, s[4:7], s33 offen sc1
  s_add_u32 s33, s33, 196608
  s_mov_b32 s44, 0
  s_branch PHB
K1_gu:
  s_sub_u32 s50, s50, 3
  s_mul_i32 s52, s51, 5
  s_lshl_b32 s53, s51, 2
  s_add_u32 s53, s53, 2
  s_cmp_lt_u32 s51, 2
  s_cselect_b32 s52, s52, s53
  s_cselect_b32 s53, 5, 4
  s_cmp_ge_u32 s50, s53
  s_cbranch_scc1 K1_pack
  s_add_u32 s52, s52, s50
  s_mul_i32 s22, s52, 96
  s_add_u32 s58, s52, 12
  s_and_b32 s3, s20, 3
  s_lshl_b32 s59, s3, 6
  s_lshl_b32 s26, s57, 8
  s_add_u32 s59, s59, s26

  s_mov_b32 s12, s44
  s_mov_b32 s13, s45
  s_mov_b32 s14, 2211840
  s_mov_b32 s15, 0x20000
  s_mov_b32 s16, s46
  s_mov_b32 s17, s47
  s_mov_b32 s18, 2211840
  s_mov_b32 s19, 0x20000
  s_add_u32 s4, s48, 9437184
  s_addc_u32 s5, s49, 0
  s_mov_b32 s6, 9699328
  s_mov_b32 s7, 0x20000
  s_mul_i32 s24, s20, 12288
  s_mul_i32 s25, s20, 768
  s_add_u32 s25, s25, 98304
  v_lshrrev_b32 v170, 3, v207
  v_bfe_u32 v171, v207, 1, 2
  v_and_b32 v172, 1, v207
  s_lshl_b32 s26, s20, 2
  v_add_u32 v171, s26, v171
  v_mul_u32_u24 v171, 3456, v171
  v_lshlrev_b32 v170, 5, v170
  v_lshl_add_u32 v170, v172, 4, v170
  s_lshl_b32 s26, s22, 1
  v_add3_u32 v165, v170, v171, s26

  s_add_u32 m0, s25, 0
  s_mov_b32 s31, 0
  s_mov_b32 exec_hi, 65535
  buffer_load_dwordx4 v165, s[12:15], s31 offen lds
  s_mov_b32 exec_hi, -1
  s_add_u32 m0, s25, 6272
  s_mov_b32 s31, 0
  s_mov_b32 exec_hi, 65535
  buffer_load_dwordx4 v165, s[16:19], s31 offen lds
  s_mov_b32 exec_hi, -1
  s_add_u32 m0, s24, 0
  s_movk_i32 s30, 0
  buffer_load_dwordx4 v184, s[8:11], s30 offen lds
  s_add_u32 m0, s24, 1024
  s_movk_i32 s30, 0
  buffer_load_dwordx4 v185, s[8:11], s30 offen lds
  s_add_u32 m0, s24, 2048
  s_movk_i32 s30, 0
  buffer_load_dwordx4 v186, s[8:11], s30 offen lds
  s_add_u32 m0, s24, 3072
  s_movk_i32 s30, 0
  buffer_load_dwordx4 v187, s[8:11], s30 offen lds
  s_barrier
  s_add_u32 m0, s25, 12416
  s_mov_b32 s31, 110592
  s_mov_b32 exec_hi, 65535
  buffer_load_dwordx4 v165, s[12:15], s31 offen lds
  s_mov_b32 exec_hi, -1
  s_add_u32 m0, s25, 18688
  s_mov_b32 s31, 110592
  s_mov_b32 exec_hi, 65535
  buffer_load_dwordx4 v165, s[16:19], s31 offen lds
  s_mov_b32 exec_hi, -1
  v_and_b32 v170, 31, v207
  v_lshrrev_b32 v171, 5, v207
  v_bfe_u32 v172, v207, 1, 3
  v_xor_b32 v171, v171, v172
  v_lshlrev_b32 v170, 7, v170
  v_lshl_add_u32 v170, v171, 4, v170
  s_mul_i32 s26, s20, 12288
  v_add_u32 v188, s26, v170
  v_xor_b32 v189, 32, v188
  v_xor_b32 v190, 64, v188
  v_xor_b32 v191, 96, v188
  s_mov_b32 s68, s72
  s_mov_b32 s69, s73
  s_mov_b32 s70, 256
  s_mov_b32 s71, 0x20000
  s_add_u32 s64, s48, 25165824
  s_addc_u32 s65, s49, 0
  s_mov_b32 s66, 299008
  s_mov_b32 s67, 0x20000
  s_lshl_b32 s72, s57, 5
  s_add_u32 s72, s72, s76
  s_lshl_b32 s73, s72, 3
  s_add_u32 s73, s73, s20
  s_and_b32 s3, s20, 3
  s_lshl_b32 s3, s3, 1
  s_sub_i32 s3, s3, s20
  s_mul_i32 s3, s3, 12288
  v_add_u32 v188, s3, v188
  v_add_u32 v189, s3, v189
  v_add_u32 v190, s3, v190
  v_add_u32 v191, s3, v191
  v_lshrrev_b32 v170, 5, v207
  v_bfe_u32 v171, v207, 4, 1
  v_and_b32 v172, 1, v207
  v_bfe_u32 v173, v207, 2, 2
  v_bfe_u32 v174, v207, 1, 1
  v_mul_u32_u24 v175, 6272, v171
  v_lshl_add_u32 v175, v172, 4, v175
  v_lshl_add_u32 v175, v173, 5, v175
  v_lshl_add_u32 v175, v174, 3, v175
  v_mul_u32_u24 v176, 1536, v170
  v_add_u32 v168, 98304, v175
  v_add_u32 v168, v176, v168
  s_lshr_b32 s56, s20, 2
  s_mul_i32 s26, s56, 384
  v_add_u32 v168, s26, v168
  s_waitcnt vmcnt(2) lgkmcnt(0)
  s_barrier
  ds_read_b128 v[96:99], v188 offset:0
  ds_read_b64_tr_b16 v[104:105], v168 offset:0
  ds_read_b64_tr_b16 v[106:107], v168 offset:768
  ds_read_b128 v[100:103], v188 offset:12288
  ds_read_b64_tr_b16 v[108:109], v168 offset:128
  ds_read_b64_tr_b16 v[110:111], v168 offset:896
  ds_read_b64_tr_b16 v[112:113], v168 offset:256
  ds_read_b64_tr_b16 v[114:115], v168 offset:1024
  s_add_u32 m0, s24, 4096
  s_movk_i32 s30, 128
  buffer_load_dwordx4 v184, s[8:11], s30 offen lds
  s_add_u32 m0, s24, 5120
  s_movk_i32 s30, 128
  buffer_load_dwordx4 v185, s[8:11], s30 offen lds
  s_add_u32 m0, s25, 24832
  s_mov_b32 s31, 221184
  s_mov_b32 exec_hi, 65535
  buffer_load_dwordx4 v165, s[12:15], s31 offen lds
  s_mov_b32 exec_hi, -1
  s_add_u32 m0, s25, 31104
  s_mov_b32 s31, 221184
  s_mov_b32 exec_hi, 65535
  buffer_load_dwordx4 v165, s[16:19], s31 offen lds
  s_mov_b32 exec_hi, -1
  s_add_u32 m0, s24, 6144
  s_movk_i32 s30, 128
  buffer_load_dwordx4 v186, s[8:11], s30 offen lds
  s_add_u32 m0, s24, 7168
  s_movk_i32 s30, 128
  buffer_load_dwordx4 v187, s[8:11], s30 offen lds
  s_add_u32 m0, s25, 37248
  s_mov_b32 s31, 331776
  s_mov_b32 exec_hi, 65535
  buffer_load_dwordx4 v165, s[12:15], s31 offen lds
  s_mov_b32 exec_hi, -1
  s_add_u32 m0, s25, 43520
  s_mov_b32 s31, 331776
  s_mov_b32 exec_hi, 65535
  buffer_load_dwordx4 v165, s[16:19], s31 offen lds
  s_mov_b32 exec_hi, -1
  s_waitcnt lgkmcnt(0)
  v_mfma_f32_32x32x16_bf16 v[0:15], v[104:107], v[96:99], 0
  ds_read_b128 v[124:127], v189 offset:0
  ds_read_b64_tr_b16 v[132:133], v168 offset:3072
  ds_read_b64_tr_b16 v[134:135], v168 offset:3840
  v_mfma_f32_32x32x16_bf16 v[48:63], v[104:107], v[100:103], 0
  ds_read_b128 v[128:131], v189 offset:12288
  ds_read_b64_tr_b16 v[136:137], v168 offset:3200
  ds_read_b64_tr_b16 v[138:139], v168 offset:3968
  v_mfma_f32_32x32x16_bf16 v[16:31], v[108:111], v[96:99], 0
  ds_read_b64_tr_b16 v[140:141], v168 offset:3328
  ds_read_b64_tr_b16 v[142:143], v168 offset:4096
  s_add_u32 m0, s24, 8192
  s_movk_i32 s30, 256
  buffer_load_dwordx4 v184, s[8:11], s30 offen lds
  v_mfma_f32_32x32x16_bf16 v[64:79], v[108:111], v[100:103], 0
  s_add_u32 m0, s24, 9216
  s_movk_i32 s30, 256
  buffer_load_dwordx4 v185, s[8:11], s30 offen lds
  v_mfma_f32_32x32x16_bf16 v[32:47], v[112:115], v[96:99], 0
  s_add_u32 m0, s25, 49664
  s_mov_b32 s31, 442368
  s_mov_b32 exec_hi, 65535
  buffer_load_dwordx4 v165, s[12:15], s31 offen lds
  s_mov_b32 exec_hi, -1
  v_mfma_f32_32x32x16_bf16 v[80:95], v[112:115], v[100:103], 0
  s_add_u32 m0, s25, 55936
  s_mov_b32 s31, 442368
  s_mov_b32 exec_hi, 65535
  buffer_load_dwordx4 v165, s[16:19], s31 offen lds
  s_mov_b32 exec_hi, -1
  s_waitcnt vmcnt(12) lgkmcnt(0)
  s_barrier
  v_mfma_f32_32x32x16_bf16 v[0:15], v[132:135], v[124:127], v[0:15]
  ds_read_b128 v[96:99], v190 offset:0
  ds_read_b64_tr_b16 v[104:105], v168 offset:12416
  ds_read_b64_tr_b16 v[106:107], v168 offset:13184
  v_mfma_f32_32x32x16_bf16 v[48:63], v[132:135], v[128:131], v[48:63]
  ds_read_b128 v[100:103], v190 offset:12288
  ds_read_b64_tr_b16 v[108:109], v168 offset:12544
  ds_read_b64_tr_b16 v[110:111], v168 offset:13312
  v_mfma_f32_32x32x16_bf16 v[16:31], v[136:139], v[124:127], v[16:31]
  ds_read_b64_tr_b16 v[112:113], v168 offset:12672
  ds_read_b64_tr_b16 v[114:115], v168 offset:13440
  s_add_u32 m0, s24, 10240
  s_movk_i32 s30, 256
  buffer_load_dwordx4 v186, s[8:11], s30 offen lds
  v_mfma_f32_32x32x16_bf16 v[64:79], v[136:139], v[128:131], v[64:79]
  s_add_u32 m0, s24, 11264
  s_movk_i32 s30, 256
  buffer_load_dwordx4 v187, s[8:11], s30 offen lds
  v_mfma_f32_32x32x16_bf16 v[32:47], v[140:143], v[124:127], v[32:47]
  v_mfma_f32_32x32x16_bf16 v[80:95], v[140:143], v[128:131], v[80:95]
  s_waitcnt lgkmcnt(0)
  v_mfma_f32_32x32x16_bf16 v[0:15], v[104:107], v[96:99], v[0:15]
  ds_read_b128 v[124:127], v191 offset:0
  ds_read_b64_tr_b16 v[132:133], v168 offset:15488
  ds_read_b64_tr_b16 v[134:135], v168 offset:16256
  v_mfma_f32_32x32x16_bf16 v[48:63], v[104:107], v[100:103], v[48:63]
  ds_read_b128 v[128:131], v191 offset:12288
  ds_read_b64_tr_b16 v[136:137], v168 offset:15616
  ds_read_b64_tr_b16 v[138:139], v168 offset:16384
  v_mfma_f32_32x32x16_bf16 v[16:31], v[108:111], v[96:99], v[16:31]
  ds_read_b64_tr_b16 v[140:141], v168 offset:15744
  ds_read_b64_tr_b16 v[142:143], v168 offset:16512
  s_memrealtime s[80:81]
  s_or_b32 s26, s2, s20
  s_cmp_eq_u32 s26, 0
  s_cselect_b32 s26, 0, 0x40000000
  v_mov_b32 v171, 0
  s_waitcnt lgkmcnt(0)
  s_or_b32 s80, s80, 1
  v_mov_b32 v170, s80
  buffer_store_dword v170, v171, s[68:71], s26 offen sc1
  s_mul_i32 s26, s73, 1280
  v_mul_u32_u24 v157, 20, v207
  buffer_load_dwordx4 v[152:155], v157, s[8:11], s26 offen
  buffer_load_dword v156, v157, s[8:11], s26 offen offset:16
  v_and_b32 v170, 15, v207
  v_lshrrev_b32 v171, 4, v207
  s_and_b32 s3, s20, 3
  s_lshl_b32 s26, s3, 2
  s_mul_i32 s33, s57, 80
  s_add_u32 s26, s26, s33
  v_add_u32 v172, s26, v171
  v_mul_u32_u24 v172, 3456, v172
  v_lshl_add_u32 v172, v170, 4, v172
  s_lshl_b32 s26, s22, 1
  v_add_u32 v172, s26, v172
  v_cmp_gt_u32 vcc, 12, v170
  v_mov_b32 v173, 0x40000000
  s_cmp_eq_u32 s56, 0
  s_cselect_b32 s60, s12, s16
  s_cselect_b32 s61, s13, s17
  s_cselect_b32 s62, s14, s18
  v_mfma_f32_32x32x16_bf16 v[64:79], v[108:111], v[100:103], v[64:79]
  s_mov_b32 s63, 0x20000
  v_cndmask_b32 v172, v173, v172, vcc
  s_mov_b32 s26, 0
  buffer_load_dwordx4 v[208:211], v172, s[60:63], s26 offen
  s_mov_b32 s26, 55296
  buffer_load_dwordx4 v[212:215], v172, s[60:63], s26 offen
  s_mov_b32 s26, 110592
  buffer_load_dwordx4 v[216:219], v172, s[60:63], s26 offen
  s_mov_b32 s26, 165888
  buffer_load_dwordx4 v[220:223], v172, s[60:63], s26 offen
  s_mov_b32 s26, 221184
  buffer_load_dwordx4 v[224:227], v172, s[60:63], s26 offen
  v_lshrrev_b32 v172, 1, v170
  v_and_b32 v170, 1, v170
  v_lshlrev_b32 v172, 7, v172
  v_lshl_add_u32 v172, v170, 4, v172
  v_lshrrev_b32 v170, 1, v171
  v_lshl_add_u32 v172, v170, 5, v172
  v_and_b32 v170, 1, v171
  v_lshl_add_u32 v172, v170, 3, v172
  s_lshl_b32 s26, s56, 6
  s_mul_i32 s3, s3, 768
  s_add_u32 s26, s26, s3
  s_add_u32 s26, s26, 160384
  v_add_u32 v172, s26, v172
  v_mov_b32 v173, 163456
  v_cndmask_b32 v169, v173, v172, vcc
  s_mov_b32 s29, 0x3f803f80
  v_mfma_f32_32x32x16_bf16 v[32:47], v[112:115], v[96:99], v[32:47]
  s_add_u32 m0, s25, 0
  s_mov_b32 s31, 552960
  s_mov_b32 exec_hi, 65535
  buffer_load_dwordx4 v165, s[12:15], s31 offen lds
  s_mov_b32 exec_hi, -1
  v_mfma_f32_32x32x16_bf16 v[80:95], v[112:115], v[100:103], v[80:95]
  s_add_u32 m0, s25, 6272
  s_mov_b32 s31, 552960
  s_mov_b32 exec_hi, 65535
  buffer_load_dwordx4 v165, s[16:19], s31 offen lds
  s_mov_b32 exec_hi, -1
  s_waitcnt vmcnt(18) lgkmcnt(0)
  s_barrier
  v_mfma_f32_32x32x16_bf16 v[0:15], v[132:135], v[124:127], v[0:15]
  ds_read_b128 v[96:99], v188 offset:4096
  ds_read_b64_tr_b16 v[104:105], v168 offset:24832
  ds_read_b64_tr_b16 v[106:107], v168 offset:25600
  v_mfma_f32_32x32x16_bf16 v[48:63], v[132:135], v[128:131], v[48:63]
  ds_read_b128 v[100:103], v188 offset:16384
  ds_read_b64_tr_b16 v[108:109], v168 offset:24960
  ds_read_b64_tr_b16 v[110:111], v168 offset:25728
  v_mfma_f32_32x32x16_bf16 v[16:31], v[136:139], v[124:127], v[16:31]
  ds_read_b64_tr_b16 v[112:113], v168 offset:25088
  ds_read_b64_tr_b16 v[114:115], v168 offset:25856
  s_add_u32 m0, s24, 0
  s_movk_i32 s30, 384
  buffer_load_dwordx4 v184, s[8:11], s30 offen lds
  v_mfma_f32_32x32x16_bf16 v[64:79], v[136:139], v[128:131], v[64:79]
  s_add_u32 m0, s24, 1024
  s_movk_i32 s30, 384
  buffer_load_dwordx4 v185, s[8:11], s30 offen lds
  v_mfma_f32_32x32x16_bf16 v[32:47], v[140:143], v[124:127], v[32:47]
  v_mfma_f32_32x32x16_bf16 v[80:95], v[140:143], v[128:131], v[80:95]
  s_waitcnt lgkmcnt(0)
  v_mfma_f32_32x32x16_bf16 v[0:15], v[104:107], v[96:99], v[0:15]
  ds_read_b128 v[124:127], v189 offset:4096
  ds_read_b64_tr_b16 v[132:133], v168 offset:27904
  ds_read_b64_tr_b16 v[134:135], v168 offset:28672
  v_mfma_f32_32x32x16_bf16 v[48:63], v[104:107], v[100:103], v[48:63]
  ds_read_b128 v[128:131], v189 offset:16384
  ds_read_b64_tr_b16 v[136:137], v168 offset:28032
  ds_read_b64_tr_b16 v[138:139], v168 offset:28800
  v_mfma_f32_32x32x16_bf16 v[16:31], v[108:111], v[96:99], v[16:31]
  ds_read_b64_tr_b16 v[140:141], v168 offset:28160
  ds_read_b64_tr_b16 v[142:143], v168 offset:28928
  s_add_u32 m0, s25, 12416
  s_mov_b32 s31, 663552
  s_mov_b32 exec_hi, 65535
  buffer_load_dwordx4 v165, s[12:15], s31 offen lds
  s_mov_b32 exec_hi, -1
  v_mfma_f32_32x32x16_bf16 v[64:79], v[108:111], v[100:103], v[64:79]
  s_add_u32 m0, s25, 18688
  s_mov_b32 s31, 663552
  s_mov_b32 exec_hi, 65535
  buffer_load_dwordx4 v165, s[16:19], s31 offen lds
  s_mov_b32 exec_hi, -1
  v_mfma_f32_32x32x16_bf16 v[32:47], v[112:115], v[96:99], v[32:47]
  v_mfma_f32_32x32x16_bf16 v[80:95], v[112:115], v[100:103], v[80:95]
  s_waitcnt vmcnt(20) lgkmcnt(0)
  s_barrier
  v_mfma_f32_32x32x16_bf16 v[0:15], v[132:135], v[124:127], v[0:15]
  ds_read_b128 v[96:99], v190 offset:4096
  ds_read_b64_tr_b16 v[104:105], v168 offset:37248
  ds_read_b64_tr_b16 v[106:107], v168 offset:38016
  v_mfma_f32_32x32x16_bf16 v[48:63], v[132:135], v[128:131], v[48:63]
  ds_read_b128 v[100:103], v190 offset:16384
  ds_read_b64_tr_b16 v[108:109], v168 offset:37376
  ds_read_b64_tr_b16 v[110:111], v168 offset:38144
  v_mfma_f32_32x32x16_bf16 v[16:31], v[136:139], v[124:127], v[16:31]
  ds_read_b64_tr_b16 v[112:113], v168 offset:37504
  ds_read_b64_tr_b16 v[114:115], v168 offset:38272
  s_add_u32 m0, s24, 2048
  s_movk_i32 s30, 384
  buffer_load_dwordx4 v186, s[8:11], s30 offen lds
  v_mfma_f32_32x32x16_bf16 v[64:79], v[136:139], v[128:131], v[64:79]
  s_add_u32 m0, s24, 3072
  s_movk_i32 s30, 384
  buffer_load_dwordx4 v187, s[8:11], s30 offen lds
  v_mfma_f32_32x32x16_bf16 v[32:47], v[140:143], v[124:127], v[32:47]
  v_mfma_f32_32x32x16_bf16 v[80:95], v[140:143], v[128:131], v[80:95]
  s_waitcnt lgkmcnt(0)
  v_mfma_f32_32x32x16_bf16 v[0:15], v[104:107], v[96:99], v[0:15]
  ds_read_b128 v[124:127], v191 offset:4096
  ds_read_b64_tr_b16 v[132:133], v168 offset:40320
  ds_read_b64_tr_b16 v[134:135], v168 offset:41088
  v_mfma_f32_32x32x16_bf16 v[48:63], v[104:107], v[100:103], v[48:63]
  ds_read_b128 v[128:131], v191 offset:16384
  ds_read_b64_tr_b16 v[136:137], v168 offset:40448
  ds_read_b64_tr_b16 v[138:139], v168 offset:41216
  v_mfma_f32_32x32x16_bf16 v[16:31], v[108:111], v[96:99], v[16:31]
  ds_read_b64_tr_b16 v[140:141], v168 offset:40576
  ds_read_b64_tr_b16 v[142:143], v168 offset:41344
  s_add_u32 m0, s25, 24832
  s_mov_b32 s31, 774144
  s_mov_b32 exec_hi, 65535
  buffer_load_dwordx4 v165, s[12:15], s31 offen lds
  s_mov_b32 exec_hi, -1
  v_mfma_f32_32x32x16_bf16 v[64:79], v[108:111], v[100:103], v[64:79]
  s_add_u32 m0, s25, 31104
  s_mov_b32 s31, 774144
  s_mov_b32 exec_hi, 65535
  buffer_load_dwordx4 v165, s[16:19], s31 offen lds
  s_mov_b32 exec_hi, -1
  v_mfma_f32_32x32x16_bf16 v[32:47], v[112:115], v[96:99], v[32:47]
  v_mfma_f32_32x32x16_bf16 v[80:95], v[112:115], v[100:103], v[80:95]
  s_waitcnt vmcnt(18) lgkmcnt(0)
  s_barrier
  v_mfma_f32_32x32x16_bf16 v[0:15], v[132:135], v[124:127], v[0:15]
  ds_read_b128 v[96:99], v188 offset:8192
  ds_read_b64_tr_b16 v[104:105], v168 offset:49664
  ds_read_b64_tr_b16 v[106:107], v168 offset:50432
  v_mfma_f32_32x32x16_bf16 v[48:63], v[132:135], v[128:131], v[48:63]
  ds_read_b128 v[100:103], v188 offset:20480
  ds_read_b64_tr_b16 v[108:109], v168 offset:49792
  ds_read_b64_tr_b16 v[110:111], v168 offset:50560
  v_mfma_f32_32x32x16_bf16 v[16:31], v[136:139], v[124:127], v[16:31]
  ds_read_b64_tr_b16 v[112:113], v168 offset:49920
  ds_read_b64_tr_b16 v[114:115], v168 offset:50688
  v_mov_b32 v201, 0
  buffer_load_dword v200, v201, s[68:71], 0 offen sc1
  v_mfma_f32_32x32x16_bf16 v[64:79], v[136:139], v[128:131], v[64:79]
  s_add_u32 m0, s24, 4096
  s_movk_i32 s30, 512
  buffer_load_dwordx4 v184, s[8:11], s30 offen lds
  v_mfma_f32_32x32x16_bf16 v[32:47], v[140:143], v[124:127], v[32:47]
  s_add_u32 m0, s24, 5120
  s_movk_i32 s30, 512
  buffer_load_dwordx4 v185, s[8:11], s30 offen lds
  v_mfma_f32_32x32x16_bf16 v[80:95], v[140:143], v[128:131], v[80:95]
  s_waitcnt lgkmcnt(0)
  v_mfma_f32_32x32x16_bf16 v[0:15], v[104:107], v[96:99], v[0:15]
  ds_read_b128 v[124:127], v189 offset:8192
  ds_read_b64_tr_b16 v[132:133], v168 offset:52736
  ds_read_b64_tr_b16 v[134:135], v168 offset:53504
  v_mfma_f32_32x32x16_bf16 v[48:63], v[104:107], v[100:103], v[48:63]
  ds_read_b128 v[128:131], v189 offset:20480
  ds_read_b64_tr_b16 v[136:137], v168 offset:52864
  ds_read_b64_tr_b16 v[138:139], v168 offset:53632
  v_mfma_f32_32x32x16_bf16 v[16:31], v[108:111], v[96:99], v[16:31]
  ds_read_b64_tr_b16 v[140:141], v168 offset:52992
  ds_read_b64_tr_b16 v[142:143], v168 offset:53760
  s_add_u32 m0, s25, 37248
  s_mov_b32 s31, 884736
  s_mov_b32 exec_hi, 65535
  buffer_load_dwordx4 v165, s[12:15], s31 offen lds
  s_mov_b32 exec_hi, -1
  v_mfma_f32_32x32x16_bf16 v[64:79], v[108:111], v[100:103], v[64:79]
  s_add_u32 m0, s25, 43520
  s_mov_b32 s31, 884736
  s_mov_b32 exec_hi, 65535
  buffer_load_dwordx4 v165, s[16:19], s31 offen lds
  s_mov_b32 exec_hi, -1
  v_mfma_f32_32x32x16_bf16 v[32:47], v[112:115], v[96:99], v[32:47]
  v_mfma_f32_32x32x16_bf16 v[80:95], v[112:115], v[100:103], v[80:95]
  s_waitcnt vmcnt(13) lgkmcnt(0)
  s_barrier
  v_mfma_f32_32x32x16_bf16 v[0:15], v[132:135], v[124:127], v[0:15]
  ds_read_b128 v[96:99], v190 offset:8192
  ds_read_b64_tr_b16 v[104:105], v168 offset:0
  ds_read_b64_tr_b16 v[106:107], v168 offset:768
  v_mfma_f32_32x32x16_bf16 v[48:63], v[132:135], v[128:131], v[48:63]
  ds_read_b128 v[100:103], v190 offset:20480
  ds_read_b64_tr_b16 v[108:109], v168 offset:128
  ds_read_b64_tr_b16 v[110:111], v168 offset:896
  v_mfma_f32_32x32x16_bf16 v[16:31], v[136:139], v[124:127], v[16:31]
  ds_read_b64_tr_b16 v[112:113], v168 offset:256
  ds_read_b64_tr_b16 v[114:115], v168 offset:1024
  v_lshlrev_b32 v192, 16, v152
  v_and_b32 v193, s32, v152
  v_add_f32 v158, v192, v193
  v_mul_f32 v159, v192, v192
  v_fmac_f32 v159, v193, v193
  v_lshlrev_b32 v192, 16, v153
  v_and_b32 v193, s32, v153
  v_add_f32 v158, v158, v192
  v_fmac_f32 v159, v192, v192
  v_add_f32 v158, v158, v193
  v_fmac_f32 v159, v193, v193
  v_lshlrev_b32 v192, 16, v154
  v_and_b32 v193, s32, v154
  v_add_f32 v158, v158, v192
  v_mfma_f32_32x32x16_bf16 v[64:79], v[136:139], v[128:131], v[64:79]
  v_fmac_f32 v159, v192, v192
  v_add_f32 v158, v158, v193
  v_fmac_f32 v159, v193, v193
  v_lshlrev_b32 v192, 16, v155
  v_and_b32 v193, s32, v155
  v_add_f32 v158, v158, v192
  v_fmac_f32 v159, v192, v192
  v_mfma_f32_32x32x16_bf16 v[32:47], v[140:143], v[124:127], v[32:47]
  s_add_u32 m0, s24, 6144
  s_movk_i32 s30, 512
  buffer_load_dwordx4 v186, s[8:11], s30 offen lds
  v_mfma_f32_32x32x16_bf16 v[80:95], v[140:143], v[128:131], v[80:95]
  s_add_u32 m0, s24, 7168
  s_movk_i32 s30, 512
  buffer_load_dwordx4 v187, s[8:11], s30 offen lds
  s_waitcnt lgkmcnt(0)
  v_mfma_f32_32x32x16_bf16 v[0:15], v[104:107], v[96:99], v[0:15]
  ds_read_b128 v[124:127], v191 offset:8192
  ds_read_b64_tr_b16 v[132:133], v168 offset:3072
  ds_read_b64_tr_b16 v[134:135], v168 offset:3840
  v_mfma_f32_32x32x16_bf16 v[48:63], v[104:107], v[100:103], v[48:63]
  ds_read_b128 v[128:131], v191 offset:20480
  ds_read_b64_tr_b16 v[136:137], v168 offset:3200
  ds_read_b64_tr_b16 v[138:139], v168 offset:3968
  v_mfma_f32_32x32x16_bf16 v[16:31], v[108:111], v[96:99], v[16:31]
  ds_read_b64_tr_b16 v[140:141], v168 offset:3328
  ds_read_b64_tr_b16 v[142:143], v168 offset:4096
  v_add_f32 v158, v158, v193
  v_fmac_f32 v159, v193, v193
  v_lshlrev_b32 v192, 16, v156
  v_and_b32 v193, s32, v156
  v_add_f32 v158, v158, v192
  v_fmac_f32 v159, v192, v192
  v_add_f32 v158, v158, v193
  v_fmac_f32 v159, v193, v193
  s_nop 1
  v_add_f32_dpp v158, v158, v158 row_shr:1 bound_ctrl:0
  v_add_f32_dpp v159, v159, v159 row_shr:1 bound_ctrl:0
  s_nop 1
  v_add_f32_dpp v158, v158, v158 row_shr:2 bound_ctrl:0
  v_add_f32_dpp v159, v159, v159 row_shr:2 bound_ctrl:0
  v_mfma_f32_32x32x16_bf16 v[64:79], v[108:111], v[100:103], v[64:79]
  s_nop 1
  v_add_f32_dpp v158, v158, v158 row_shr:4 bound_ctrl:0
  v_add_f32_dpp v159, v159, v159 row_shr:4 bound_ctrl:0
  s_nop 1
  v_add_f32_dpp v158, v158, v158 row_shr:8 bound_ctrl:0
  v_add_f32_dpp v159, v159, v159 row_shr:8 bound_ctrl:0
  s_nop 1
  v_mfma_f32_32x32x16_bf16 v[32:47], v[112:115], v[96:99], v[32:47]
  s_add_u32 m0, s25, 49664
  s_mov_b32 s31, 995328
  s_mov_b32 exec_hi, 65535
  buffer_load_dwordx4 v165, s[12:15], s31 offen lds
  s_mov_b32 exec_hi, -1
  v_mfma_f32_32x32x16_bf16 v[80:95], v[112:115], v[100:103], v[80:95]
  s_add_u32 m0, s25, 55936
  s_mov_b32 s31, 995328
  s_mov_b32 exec_hi, 65535
  buffer_load_dwordx4 v165, s[16:19], s31 offen lds
  s_mov_b32 exec_hi, -1
  s_waitcnt vmcnt(11) lgkmcnt(0)
  s_barrier
  v_mfma_f32_32x32x16_bf16 v[0:15], v[132:135], v[124:127], v[0:15]
  ds_read_b128 v[96:99], v188 offset:0
  ds_read_b64_tr_b16 v[104:105], v168 offset:12416
  ds_read_b64_tr_b16 v[106:107], v168 offset:13184
  v_mfma_f32_32x32x16_bf16 v[48:63], v[132:135], v[128:131], v[48:63]
  ds_read_b128 v[100:103], v188 offset:12288
  ds_read_b64_tr_b16 v[108:109], v168 offset:12544
  ds_read_b64_tr_b16 v[110:111], v168 offset:13312
  v_mfma_f32_32x32x16_bf16 v[16:31], v[136:139], v[124:127], v[16:31]
  ds_read_b64_tr_b16 v[112:113], v168 offset:12672
  ds_read_b64_tr_b16 v[114:115], v168 offset:13440
  v_add_f32_dpp v158, v158, v158 row_bcast:15 row_mask:0xa
  v_add_f32_dpp v159, v159, v159 row_bcast:15 row_mask:0xa
  s_nop 1
  v_add_f32_dpp v158, v158, v158 row_bcast:31 row_mask:0xc
  v_add_f32_dpp v159, v159, v159 row_bcast:31 row_mask:0xc
  v_mul_f32 v158, 0xbacccccd, v158
  v_mul_f32 v159, 0x3acccccd, v159
  v_fma_f32 v159, -v158, v158, v159
  v_max_f32 v159, 0, v159
  v_add_f32 v159, 0x3727c5ac, v159
  v_rsq_f32 v159, v159
  v_cmp_eq_u32 vcc, 63, v207
  v_mov_b32 v192, 0x40000000
  s_lshl_b32 s26, s73, 3
  v_mfma_f32_32x32x16_bf16 v[64:79], v[136:139], v[128:131], v[64:79]
  v_cndmask_b32 v192, v192, 0, vcc
  buffer_store_dwordx2 v[158:159], v192, s[64:67], s26 offen sc1
  v_lshlrev_b32 v192, 16, v208
  v_lshlrev_b32 v171, 16, v212
  v_add_f32 v192, v192, v171
  v_lshlrev_b32 v170, 16, v216
  v_add_f32 v192, v192, v170
  v_mfma_f32_32x32x16_bf16 v[32:47], v[140:143], v[124:127], v[32:47]
  s_add_u32 m0, s24, 8192
  s_movk_i32 s30, 640
  buffer_load_dwordx4 v184, s[8:11], s30 offen lds
  v_mfma_f32_32x32x16_bf16 v[80:95], v[140:143], v[128:131], v[80:95]
  s_add_u32 m0, s24, 9216
  s_movk_i32 s30, 640
  buffer_load_dwordx4 v185, s[8:11], s30 offen lds
  s_waitcnt lgkmcnt(0)
  v_mfma_f32_32x32x16_bf16 v[0:15], v[104:107], v[96:99], v[0:15]
  ds_read_b128 v[124:127], v189 offset:0
  ds_read_b64_tr_b16 v[132:133], v168 offset:15488
  ds_read_b64_tr_b16 v[134:135], v168 offset:16256
  v_mfma_f32_32x32x16_bf16 v[48:63], v[104:107], v[100:103], v[48:63]
  ds_read_b128 v[128:131], v189 offset:12288
  ds_read_b64_tr_b16 v[136:137], v168 offset:15616
  ds_read_b64_tr_b16 v[138:139], v168 offset:16384
  v_mfma_f32_32x32x16_bf16 v[16:31], v[108:111], v[96:99], v[16:31]
  ds_read_b64_tr_b16 v[140:141], v168 offset:15744
  ds_read_b64_tr_b16 v[142:143], v168 offset:16512
  v_lshlrev_b32 v171, 16, v220
  v_add_f32 v192, v192, v171
  v_lshlrev_b32 v170, 16, v224
  v_add_f32 v192, v192, v170
  v_and_b32 v193, s32, v208
  v_and_b32 v171, s32, v212
  v_add_f32 v193, v193, v171
  v_and_b32 v170, s32, v216
  v_add_f32 v193, v193, v170
  v_and_b32 v171, s32, v220
  v_add_f32 v193, v193, v171
  v_and_b32 v170, s32, v224
  v_add_f32 v193, v193, v170
  v_lshlrev_b32 v194, 16, v209
  v_mfma_f32_32x32x16_bf16 v[64:79], v[108:111], v[100:103], v[64:79]
  v_lshlrev_b32 v171, 16, v213
  v_add_f32 v194, v194, v171
  v_lshlrev_b32 v170, 16, v217
  v_add_f32 v194, v194, v170
  v_lshlrev_b32 v171, 16, v221
  v_add_f32 v194, v194, v171
  v_lshlrev_b32 v170, 16, v225
  v_mfma_f32_32x32x16_bf16 v[32:47], v[112:115], v[96:99], v[32:47]
  s_add_u32 m0, s25, 0
  s_mov_b32 s31, 1105920
  s_mov_b32 exec_hi, 65535
  buffer_load_dwordx4 v165, s[12:15], s31 offen lds
  s_mov_b32 exec_hi, -1
  v_mfma_f32_32x32x16_bf16 v[80:95], v[112:115], v[100:103], v[80:95]
  s_add_u32 m0, s25, 6272
  s_mov_b32 s31, 1105920
  s_mov_b32 exec_hi, 65535
  buffer_load_dwordx4 v165, s[16:19], s31 offen lds
  s_mov_b32 exec_hi, -1
  s_waitcnt vmcnt(14) lgkmcnt(0)
  s_barrier
  v_mfma_f32_32x32x16_bf16 v[0:15], v[132:135], v[124:127], v[0:15]
  ds_read_b128 v[96:99], v190 offset:0
  ds_read_b64_tr_b16 v[104:105], v168 offset:24832
  ds_read_b64_tr_b16 v[106:107], v168 offset:25600
  v_mfma_f32_32x32x16_bf16 v[48:63], v[132:135], v[128:131], v[48:63]
  ds_read_b128 v[100:103], v190 offset:12288
  ds_read_b64_tr_b16 v[108:109], v168 offset:24960
  ds_read_b64_tr_b16 v[110:111], v168 offset:25728
  v_mfma_f32_32x32x16_bf16 v[16:31], v[136:139], v[124:127], v[16:31]
  ds_read_b64_tr_b16 v[112:113], v168 offset:25088
  ds_read_b64_tr_b16 v[114:115], v168 offset:25856
  v_add_f32 v194, v194, v170
  v_and_b32 v195, s32, v209
  v_and_b32 v171, s32, v213
  v_add_f32 v195, v195, v171
  v_and_b32 v170, s32, v217
  v_add_f32 v195, v195, v170
  v_and_b32 v171, s32, v221
  v_add_f32 v195, v195, v171
  v_and_b32 v170, s32, v225
  v_add_f32 v195, v195, v170
  v_lshlrev_b32 v196, 16, v210
  v_lshlrev_b32 v171, 16, v214
  v_add_f32 v196, v196, v171
  v_lshlrev_b32 v170, 16, v218
  v_mfma_f32_32x32x16_bf16 v[64:79], v[136:139], v[128:131], v[64:79]
  v_add_f32 v196, v196, v170
  v_lshlrev_b32 v171, 16, v222
  v_add_f32 v196, v196, v171
  v_lshlrev_b32 v170, 16, v226
  v_add_f32 v196, v196, v170
  v_and_b32 v197, s32, v210
  v_and_b32 v171, s32, v214
  v_mfma_f32_32x32x16_bf16 v[32:47], v[140:143], v[124:127], v[32:47]
  s_add_u32 m0, s24, 10240
  s_movk_i32 s30, 640
  buffer_load_dwordx4 v186, s[8:11], s30 offen lds
  v_mfma_f32_32x32x16_bf16 v[80:95], v[140:143], v[128:131], v[80:95]
  s_add_u32 m0, s24, 11264
  s_movk_i32 s30, 640
  buffer_load_dwordx4 v187, s[8:11], s30 offen lds
  s_waitcnt lgkmcnt(0)
  v_mfma_f32_32x32x16_bf16 v[0:15], v[104:107], v[96:99], v[0:15]
  ds_read_b128 v[124:127], v191 offset:0
  ds_read_b64_tr_b16 v[132:133], v168 offset:27904
  ds_read_b64_tr_b16 v[134:135], v168 offset:28672
  v_mfma_f32_32x32x16_bf16 v[48:63], v[104:107], v[100:103], v[48:63]
  ds_read_b128 v[128:131], v191 offset:12288
  ds_read_b64_tr_b16 v[136:137], v168 offset:28032
  ds_read_b64_tr_b16 v[138:139], v168 offset:28800
  v_mfma_f32_32x32x16_bf16 v[16:31], v[108:111], v[96:99], v[16:31]
  ds_read_b64_tr_b16 v[140:141], v168 offset:28160
  ds_read_b64_tr_b16 v[142:143], v168 offset:28928
  v_add_f32 v197, v197, v171
  v_and_b32 v170, s32, v218
  v_add_f32 v197, v197, v170
  v_and_b32 v171, s32, v222
  v_add_f32 v197, v197, v171
  v_and_b32 v170, s32, v226
  v_add_f32 v197, v197, v170
  v_lshlrev_b32 v198, 16, v211
  v_lshlrev_b32 v171, 16, v215
  v_add_f32 v198, v198, v171
  v_lshlrev_b32 v170, 16, v219
  v_add_f32 v198, v198, v170
  v_lshlrev_b32 v171, 16, v223
  v_add_f32 v198, v198, v171
  v_mfma_f32_32x32x16_bf16 v[64:79], v[108:111], v[100:103], v[64:79]
  v_lshlrev_b32 v170, 16, v227
  v_add_f32 v198, v198, v170
  v_and_b32 v199, s32, v211
  v_and_b32 v171, s32, v215
  v_add_f32 v199, v199, v171
  v_and_b32 v170, s32, v219
  v_add_f32 v199, v199, v170
  v_mfma_f32_32x32x16_bf16 v[32:47], v[112:115], v[96:99], v[32:47]
  s_add_u32 m0, s25, 12416
  s_mov_b32 s31, 1216512
  s_mov_b32 exec_hi, 65535
  buffer_load_dwordx4 v165, s[12:15], s31 offen lds
  s_mov_b32 exec_hi, -1
  v_mfma_f32_32x32x16_bf16 v[80:95], v[112:115], v[100:103], v[80:95]
  s_add_u32 m0, s25, 18688
  s_mov_b32 s31, 1216512
  s_mov_b32 exec_hi, 65535
  buffer_load_dwordx4 v165, s[16:19], s31 offen lds
  s_mov_b32 exec_hi, -1
  s_waitcnt vmcnt(11) lgkmcnt(0)
  s_barrier
  v_mfma_f32_32x32x16_bf16 v[0:15], v[132:135], v[124:127], v[0:15]
  ds_read_b128 v[96:99], v188 offset:4096
  ds_read_b64_tr_b16 v[104:105], v168 offset:37248
  ds_read_b64_tr_b16 v[106:107], v168 offset:38016
  v_mfma_f32_32x32x16_bf16 v[48:63], v[132:135], v[128:131], v[48:63]
  ds_read_b128 v[100:103], v188 offset:16384
  ds_read_b64_tr_b16 v[108:109], v168 offset:37376
  ds_read_b64_tr_b16 v[110:111], v168 offset:38144
  v_mfma_f32_32x32x16_bf16 v[16:31], v[136:139], v[124:127], v[16:31]
  ds_read_b64_tr_b16 v[112:113], v168 offset:37504
  ds_read_b64_tr_b16 v[114:115], v168 offset:38272
  v_and_b32 v171, s32, v223
  v_add_f32 v199, v199, v171
  v_and_b32 v170, s32, v227
  v_add_f32 v199, v199, v170
  s_nop 1
  v_permlane32_swap_b32 v192, v196
  v_permlane32_swap_b32 v193, v197
  v_permlane32_swap_b32 v194, v198
  v_permlane32_swap_b32 v195, v199
  s_nop 1
  v_add_f32 v192, v192, v196
  v_add_f32 v193, v193, v197
  v_add_f32 v194, v194, v198
  v_add_f32 v195, v195, v199
  v_mfma_f32_32x32x16_bf16 v[64:79], v[136:139], v[128:131], v[64:79]
  s_nop 1
  v_permlane16_swap_b32 v192, v194
  v_permlane16_swap_b32 v193, v195
  s_nop 1
  v_add_f32 v192, v192, v194
  v_add_f32 v193, v193, v195
  ds_write_b64 v169, v[192:193]
  v_mfma_f32_32x32x16_bf16 v[32:47], v[140:143], v[124:127], v[32:47]
  s_add_u32 m0, s24, 0
  s_movk_i32 s30, 768
  buffer_load_dwordx4 v184, s[8:11], s30 offen lds
  v_mfma_f32_32x32x16_bf16 v[80:95], v[140:143], v[128:131], v[80:95]
  s_add_u32 m0, s24, 1024
  s_movk_i32 s30, 768
  buffer_load_dwordx4 v185, s[8:11], s30 offen lds
  s_waitcnt lgkmcnt(0)
  v_mfma_f32_32x32x16_bf16 v[0:15], v[104:107], v[96:99], v[0:15]
  ds_read_b128 v[124:127], v189 offset:4096
  ds_read_b64_tr_b16 v[132:133], v168 offset:40320
  ds_read_b64_tr_b16 v[134:135], v168 offset:41088
  v_mfma_f32_32x32x16_bf16 v[48:63], v[104:107], v[100:103], v[48:63]
  ds_read_b128 v[128:131], v189 offset:16384
  ds_read_b64_tr_b16 v[136:137], v168 offset:40448
  ds_read_b64_tr_b16 v[138:139], v168 offset:41216
  v_mfma_f32_32x32x16_bf16 v[16:31], v[108:111], v[96:99], v[16:31]
  ds_read_b64_tr_b16 v[140:141], v168 offset:40576
  ds_read_b64_tr_b16 v[142:143], v168 offset:41344
  s_add_u32 m0, s25, 24832
  s_mov_b32 s31, 1327104
  s_mov_b32 exec_hi, 65535
  buffer_load_dwordx4 v165, s[12:15], s31 offen lds
  s_mov_b32 exec_hi, -1
  v_mfma_f32_32x32x16_bf16 v[64:79], v[108:111], v[100:103], v[64:79]
  s_add_u32 m0, s25, 31104
  s_mov_b32 s31, 1327104
  s_mov_b32 exec_hi, 65535
  buffer_load_dwordx4 v165, s[16:19], s31 offen lds
  s_mov_b32 exec_hi, -1
  v_mfma_f32_32x32x16_bf16 v[32:47], v[112:115], v[96:99], v[32:47]
  v_mfma_f32_32x32x16_bf16 v[80:95], v[112:115], v[100:103], v[80:95]
  s_waitcnt vmcnt(13) lgkmcnt(0)
  s_barrier
  v_mfma_f32_32x32x16_bf16 v[0:15], v[132:135], v[124:127], v[0:15]
  ds_read_b128 v[96:99], v190 offset:4096
  ds_read_b64_tr_b16 v[104:105], v168 offset:49664
  ds_read_b64_tr_b16 v[106:107], v168 offset:50432
  v_mfma_f32_32x32x16_bf16 v[48:63], v[132:135], v[128:131], v[48:63]
  ds_read_b128 v[100:103], v190 offset:16384
  ds_read_b64_tr_b16 v[108:109], v168 offset:49792
  ds_read_b64_tr_b16 v[110:111], v168 offset:50560
  v_mfma_f32_32x32x16_bf16 v[16:31], v[136:139], v[124:127], v[16:31]
  ds_read_b64_tr_b16 v[112:113], v168 offset:49920
  ds_read_b64_tr_b16 v[114:115], v168 offset:50688
  v_lshl_add_u32 v192, s20, 6, v207
  v_cmp_gt_u32 vcc, 192, v192
  v_lshlrev_b32 v192, 2, v192
  v_add_u32 v193, 160384, v192
  ds_read_b32 v194, v193
  ds_read_b32 v195, v193 offset:768
  ds_read_b32 v196, v193 offset:1536
  ds_read_b32 v197, v193 offset:2304
  v_mov_b32 v193, 0x40000000
  s_lshl_b32 s26, s58, 3
  s_add_u32 s26, s26, s57
  s_mul_i32 s33, s26, 768
  s_add_u32 s33, s33, 114688
  v_cndmask_b32 v192, v193, v192, vcc
  v_mfma_f32_32x32x16_bf16 v[64:79], v[136:139], v[128:131], v[64:79]
  s_add_u32 m0, s24, 2048
  s_movk_i32 s30, 768
  buffer_load_dwordx4 v186, s[8:11], s30 offen lds
  v_mfma_f32_32x32x16_bf16 v[32:47], v[140:143], v[124:127], v[32:47]
  s_add_u32 m0, s24, 3072
  s_movk_i32 s30, 768
  buffer_load_dwordx4 v187, s[8:11], s30 offen lds
  v_mfma_f32_32x32x16_bf16 v[80:95], v[140:143], v[128:131], v[80:95]
  s_waitcnt lgkmcnt(0)
  v_mfma_f32_32x32x16_bf16 v[0:15], v[104:107], v[96:99], v[0:15]
  ds_read_b128 v[124:127], v191 offset:4096
  ds_read_b64_tr_b16 v[132:133], v168 offset:52736
  ds_read_b64_tr_b16 v[134:135], v168 offset:53504
  v_mfma_f32_32x32x16_bf16 v[48:63], v[104:107], v[100:103], v[48:63]
  ds_read_b128 v[128:131], v191 offset:16384
  ds_read_b64_tr_b16 v[136:137], v168 offset:52864
  ds_read_b64_tr_b16 v[138:139], v168 offset:53632
  v_mfma_f32_32x32x16_bf16 v[16:31], v[108:111], v[96:99], v[16:31]
  ds_read_b64_tr_b16 v[140:141], v168 offset:52992
  ds_read_b64_tr_b16 v[142:143], v168 offset:53760
  v_add_f32 v194, v194, v195
  v_add_f32 v196, v196, v197
  v_add_f32 v194, v194, v196
  buffer_store_dword v194, v192, s[64:67], s33 offen sc1
  v_mfma_f32_32x32x16_bf16 v[64:79], v[108:111], v[100:103], v[64:79]
  s_add_u32 m0, s25, 37248
  s_mov_b32 s31, 1437696
  s_mov_b32 exec_hi, 65535
  buffer_load_dwordx4 v165, s[12:15], s31 offen lds
  s_mov_b32 exec_hi, -1
  v_mfma_f32_32x32x16_bf16 v[32:47], v[112:115], v[96:99], v[32:47]
  s_add_u32 m0, s25, 43520
  s_mov_b32 s31, 1437696
  s_mov_b32 exec_hi, 65535
  buffer_load_dwordx4 v165, s[16:19], s31 offen lds
  s_mov_b32 exec_hi, -1
  v_mfma_f32_32x32x16_bf16 v[80:95], v[112:115], v[100:103], v[80:95]
  s_waitcnt vmcnt(11) lgkmcnt(0)
  s_barrier
  v_mfma_f32_32x32x16_bf16 v[0:15], v[132:135], v[124:127], v[0:15]
  ds_read_b128 v[96:99], v188 offset:8192
  ds_read_b64_tr_b16 v[104:105], v168 offset:0
  ds_read_b64_tr_b16 v[106:107], v168 offset:768
  v_mfma_f32_32x32x16_bf16 v[48:63], v[132:135], v[128:131], v[48:63]
  ds_read_b128 v[100:103], v188 offset:20480
  ds_read_b64_tr_b16 v[108:109], v168 offset:128
  ds_read_b64_tr_b16 v[110:111], v168 offset:896
  v_mfma_f32_32x32x16_bf16 v[16:31], v[136:139], v[124:127], v[16:31]
  ds_read_b64_tr_b16 v[112:113], v168 offset:256
  ds_read_b64_tr_b16 v[114:115], v168 offset:1024
  v_readfirstlane_b32 s82, v200
  s_cmp_lg_u32 s82, 0
  s_cbranch_scc1 NGG_done
  v_mov_b32 v192, 0
  s_mov_b32 s26, 0x100000
NGG_loop:
  buffer_load_dword v193, v192, s[68:71], 0 offen sc1
  s_sub_u32 s26, s26, 1
  s_cbranch_scc1 NGG_done
  s_waitcnt vmcnt(0)
  v_readfirstlane_b32 s82, v193
  s_cmp_eq_u32 s82, 0
  s_cbranch_scc1 NGG_loop
NGG_done:
  v_mfma_f32_32x32x16_bf16 v[64:79], v[136:139], v[128:131], v[64:79]
  s_add_u32 m0, s24, 4096
  s_movk_i32 s30, 896
  buffer_load_dwordx4 v184, s[8:11], s30 offen lds
  v_mfma_f32_32x32x16_bf16 v[32:47], v[140:143], v[124:127], v[32:47]
  s_add_u32 m0, s24, 5120
  s_movk_i32 s30, 896
  buffer_load_dwordx4 v185, s[8:11], s30 offen lds
  v_mfma_f32_32x32x16_bf16 v[80:95], v[140:143], v[128:131], v[80:95]
  s_waitcnt lgkmcnt(0)
  v_mfma_f32_32x32x16_bf16 v[0:15], v[104:107], v[96:99], v[0:15]
  ds_read_b128 v[124:127], v189 offset:8192
  ds_read_b64_tr_b16 v[132:133], v168 offset:3072
  ds_read_b64_tr_b16 v[134:135], v168 offset:3840
  v_mfma_f32_32x32x16_bf16 v[48:63], v[104:107], v[100:103], v[48:63]
  ds_read_b128 v[128:131], v189 offset:20480
  ds_read_b64_tr_b16 v[136:137], v168 offset:3200
  ds_read_b64_tr_b16 v[138:139], v168 offset:3968
  v_mfma_f32_32x32x16_bf16 v[16:31], v[108:111], v[96:99], v[16:31]
  ds_read_b64_tr_b16 v[140:141], v168 offset:3328
  ds_read_b64_tr_b16 v[142:143], v168 offset:4096
  s_add_u32 m0, s25, 49664
  s_mov_b32 s31, 1548288
  s_mov_b32 exec_hi, 65535
  buffer_load_dwordx4 v165, s[12:15], s31 offen lds
  s_mov_b32 exec_hi, -1
  v_mfma_f32_32x32x16_bf16 v[64:79], v[108:111], v[100:103], v[64:79]
  s_add_u32 m0, s25, 55936
  s_mov_b32 s31, 1548288
  s_mov_b32 exec_hi, 65535
  buffer_load_dwordx4 v165, s[16:19], s31 offen lds
  s_mov_b32 exec_hi, -1
  v_mfma_f32_32x32x16_bf16 v[32:47], v[112:115], v[96:99], v[32:47]
  v_mfma_f32_32x32x16_bf16 v[80:95], v[112:115], v[100:103], v[80:95]
  s_waitcnt vmcnt(13) lgkmcnt(0)
  s_barrier
  v_mfma_f32_32x32x16_bf16 v[0:15], v[132:135], v[124:127], v[0:15]
  ds_read_b128 v[96:99], v190 offset:8192
  ds_read_b64_tr_b16 v[104:105], v168 offset:12416
  ds_read_b64_tr_b16 v[106:107], v168 offset:13184
  v_mfma_f32_32x32x16_bf16 v[48:63], v[132:135], v[128:131], v[48:63]
  ds_read_b128 v[100:103], v190 offset:20480
  ds_read_b64_tr_b16 v[108:109], v168 offset:12544
  ds_read_b64_tr_b16 v[110:111], v168 offset:13312
  v_mfma_f32_32x32x16_bf16 v[16:31], v[136:139], v[124:127], v[16:31]
  ds_read_b64_tr_b16 v[112:113], v168 offset:12672
  ds_read_b64_tr_b16 v[114:115], v168 offset:13440
  s_add_u32 m0, s24, 6144
  s_movk_i32 s30, 896
  buffer_load_dwordx4 v186, s[8:11], s30 offen lds
  v_mfma_f32_32x32x16_bf16 v[64:79], v[136:139], v[128:131], v[64:79]
  s_add_u32 m0, s24, 7168
  s_movk_i32 s30, 896
  buffer_load_dwordx4 v187, s[8:11], s30 offen lds
  v_mfma_f32_32x32x16_bf16 v[32:47], v[140:143], v[124:127], v[32:47]
  v_mfma_f32_32x32x16_bf16 v[80:95], v[140:143], v[128:131], v[80:95]
  s_waitcnt lgkmcnt(0)
  v_mfma_f32_32x32x16_bf16 v[0:15], v[104:107], v[96:99], v[0:15]
  ds_read_b128 v[124:127], v191 offset:8192
  ds_read_b64_tr_b16 v[132:133], v168 offset:15488
  ds_read_b64_tr_b16 v[134:135], v168 offset:16256
  v_mfma_f32_32x32x16_bf16 v[48:63], v[104:107], v[100:103], v[48:63]
  ds_read_b128 v[128:131], v191 offset:20480
  ds_read_b64_tr_b16 v[136:137], v168 offset:15616
  ds_read_b64_tr_b16 v[138:139], v168 offset:16384
  v_mfma_f32_32x32x16_bf16 v[16:31], v[108:111], v[96:99], v[16:31]
  ds_read_b64_tr_b16 v[140:141], v168 offset:15744
  ds_read_b64_tr_b16 v[142:143], v168 offset:16512
  s_add_u32 m0, s25, 0
  s_mov_b32 s31, 1658880
  s_mov_b32 exec_hi, 65535
  buffer_load_dwordx4 v165, s[12:15], s31 offen lds
  s_mov_b32 exec_hi, -1
  v_mfma_f32_32x32x16_bf16 v[64:79], v[108:111], v[100:103], v[64:79]
  s_add_u32 m0, s25, 6272
  s_mov_b32 s31, 1658880
  s_mov_b32 exec_hi, 65535
  buffer_load_dwordx4 v165, s[16:19], s31 offen lds
  s_mov_b32 exec_hi, -1
  v_mfma_f32_32x32x16_bf16 v[32:47], v[112:115], v[96:99], v[32:47]
  v_mfma_f32_32x32x16_bf16 v[80:95], v[112:115], v[100:103], v[80:95]
  s_waitcnt vmcnt(10) lgkmcnt(0)
  s_barrier
  v_mfma_f32_32x32x16_bf16 v[0:15], v[132:135], v[124:127], v[0:15]
  ds_read_b128 v[96:99], v188 offset:0
  ds_read_b64_tr_b16 v[104:105], v168 offset:24832
  ds_read_b64_tr_b16 v[106:107], v168 offset:25600
  v_mfma_f32_32x32x16_bf16 v[48:63], v[132:135], v[128:131], v[48:63]
  ds_read_b128 v[100:103], v188 offset:12288
  ds_read_b64_tr_b16 v[108:109], v168 offset:24960
  ds_read_b64_tr_b16 v[110:111], v168 offset:25728
  v_mfma_f32_32x32x16_bf16 v[16:31], v[136:139], v[124:127], v[16:31]
  ds_read_b64_tr_b16 v[112:113], v168 offset:25088
  ds_read_b64_tr_b16 v[114:115], v168 offset:25856
  v_cmp_eq_u32 vcc, 0, v207
  v_mov_b32 v192, 0x40000000
  s_lshl_b32 s26, s72, 7
  s_add_u32 s26, s26, 16384
  s_cmp_eq_u32 s20, 0
  s_cselect_b32 s26, s26, 0x40000000
  v_mov_b32 v193, s82
  v_cndmask_b32 v192, v192, 0, vcc
  buffer_store_dword v193, v192, s[64:67], s26 offen sc1
  v_mfma_f32_32x32x16_bf16 v[64:79], v[136:139], v[128:131], v[64:79]
  s_add_u32 m0, s24, 8192
  s_movk_i32 s30, 1024
  buffer_load_dwordx4 v184, s[8:11], s30 offen lds
  v_mfma_f32_32x32x16_bf16 v[32:47], v[140:143], v[124:127], v[32:47]
  s_add_u32 m0, s24, 9216
  s_movk_i32 s30, 1024
  buffer_load_dwordx4 v185, s[8:11], s30 offen lds
  v_mfma_f32_32x32x16_bf16 v[80:95], v[140:143], v[128:131], v[80:95]
  s_waitcnt lgkmcnt(0)
  v_mfma_f32_32x32x16_bf16 v[0:15], v[104:107], v[96:99], v[0:15]
  ds_read_b128 v[124:127], v189 offset:0
  ds_read_b64_tr_b16 v[132:133], v168 offset:27904
  ds_read_b64_tr_b16 v[134:135], v168 offset:28672
  v_mfma_f32_32x32x16_bf16 v[48:63], v[104:107], v[100:103], v[48:63]
  ds_read_b128 v[128:131], v189 offset:12288
  ds_read_b64_tr_b16 v[136:137], v168 offset:28032
  ds_read_b64_tr_b16 v[138:139], v168 offset:28800
  v_mfma_f32_32x32x16_bf16 v[16:31], v[108:111], v[96:99], v[16:31]
  ds_read_b64_tr_b16 v[140:141], v168 offset:28160
  ds_read_b64_tr_b16 v[142:143], v168 offset:28928
  s_add_u32 m0, s25, 12416
  s_mov_b32 s31, 1769472
  s_mov_b32 exec_hi, 65535
  buffer_load_dwordx4 v165, s[12:15], s31 offen lds
  s_mov_b32 exec_hi, -1
  v_mfma_f32_32x32x16_bf16 v[64:79], v[108:111], v[100:103], v[64:79]
  s_add_u32 m0, s25, 18688
  s_mov_b32 s31, 1769472
  s_mov_b32 exec_hi, 65535
  buffer_load_dwordx4 v165, s[16:19], s31 offen lds
  s_mov_b32 exec_hi, -1
  v_mfma_f32_32x32x16_bf16 v[32:47], v[112:115], v[96:99], v[32:47]
  v_mfma_f32_32x32x16_bf16 v[80:95], v[112:115], v[100:103], v[80:95]
  s_waitcnt vmcnt(13) lgkmcnt(0)
  s_barrier
  v_mfma_f32_32x32x16_bf16 v[0:15], v[132:135], v[124:127], v[0:15]
  ds_read_b128 v[96:99], v190 offset:0
  ds_read_b64_tr_b16 v[104:105], v168 offset:37248
  ds_read_b64_tr_b16 v[106:107], v168 offset:38016
  v_mfma_f32_32x32x16_bf16 v[48:63], v[132:135], v[128:131], v[48:63]
  ds_read_b128 v[100:103], v190 offset:12288
  ds_read_b64_tr_b16 v[108:109], v168 offset:37376
  ds_read_b64_tr_b16 v[110:111], v168 offset:38144
  v_mfma_f32_32x32x16_bf16 v[16:31], v[136:139], v[124:127], v[16:31]
  ds_read_b64_tr_b16 v[112:113], v168 offset:37504
  ds_read_b64_tr_b16 v[114:115], v168 offset:38272
  s_add_u32 m0, s24, 10240
  s_movk_i32 s30, 1024
  buffer_load_dwordx4 v186, s[8:11], s30 offen lds
  v_mfma_f32_32x32x16_bf16 v[64:79], v[136:139], v[128:131], v[64:79]
  s_add_u32 m0, s24, 11264
  s_movk_i32 s30, 1024
  buffer_load_dwordx4 v187, s[8:11], s30 offen lds
  v_mfma_f32_32x32x16_bf16 v[32:47], v[140:143], v[124:127], v[32:47]
  v_mfma_f32_32x32x16_bf16 v[80:95], v[140:143], v[128:131], v[80:95]
  s_waitcnt lgkmcnt(0)
  v_mfma_f32_32x32x16_bf16 v[0:15], v[104:107], v[96:99], v[0:15]
  ds_read_b128 v[124:127], v191 offset:0
  ds_read_b64_tr_b16 v[132:133], v168 offset:40320
  ds_read_b64_tr_b16 v[134:135], v168 offset:41088
  v_mfma_f32_32x32x16_bf16 v[48:63], v[104:107], v[100:103], v[48:63]
  ds_read_b128 v[128:131], v191 offset:12288
  ds_read_b64_tr_b16 v[136:137], v168 offset:40448
  ds_read_b64_tr_b16 v[138:139], v168 offset:41216
  v_mfma_f32_32x32x16_bf16 v[16:31], v[108:111], v[96:99], v[16:31]
  ds_read_b64_tr_b16 v[140:141], v168 offset:40576
  ds_read_b64_tr_b16 v[142:143], v168 offset:41344
  s_add_u32 m0, s25, 24832
  s_mov_b32 s31, 1880064
  s_mov_b32 exec_hi, 65535
  buffer_load_dwordx4 v165, s[12:15], s31 offen lds
  s_mov_b32 exec_hi, -1
  v_mfma_f32_32x32x16_bf16 v[64:79], v[108:111], v[100:103], v[64:79]
  s_add_u32 m0, s25, 31104
  s_mov_b32 s31, 1880064
  s_mov_b32 exec_hi, 65535
  buffer_load_dwordx4 v165, s[16:19], s31 offen lds
  s_mov_b32 exec_hi, -1
  v_mfma_f32_32x32x16_bf16 v[32:47], v[112:115], v[96:99], v[32:47]
  v_mfma_f32_32x32x16_bf16 v[80:95], v[112:115], v[100:103], v[80:95]
  s_waitcnt vmcnt(11) lgkmcnt(0)
  s_barrier
  v_mfma_f32_32x32x16_bf16 v[0:15], v[132:135], v[124:127], v[0:15]
  ds_read_b128 v[96:99], v188 offset:4096
  ds_read_b64_tr_b16 v[104:105], v168 offset:49664
  ds_read_b64_tr_b16 v[106:107], v168 offset:50432
  v_mfma_f32_32x32x16_bf16 v[48:63], v[132:135], v[128:131], v[48:63]
  ds_read_b128 v[100:103], v188 offset:16384
  ds_read_b64_tr_b16 v[108:109], v168 offset:49792
  ds_read_b64_tr_b16 v[110:111], v168 offset:50560
  v_mfma_f32_32x32x16_bf16 v[16:31], v[136:139], v[124:127], v[16:31]
  ds_read_b64_tr_b16 v[112:113], v168 offset:49920
  ds_read_b64_tr_b16 v[114:115], v168 offset:50688
  s_add_u32 m0, s24, 0
  s_movk_i32 s30, 1152
  buffer_load_dwordx4 v184, s[8:11], s30 offen lds
  v_mfma_f32_32x32x16_bf16 v[64:79], v[136:139], v[128:131], v[64:79]
  s_add_u32 m0, s24, 1024
  s_movk_i32 s30, 1152
  buffer_load_dwordx4 v185, s[8:11], s30 offen lds
  v_mfma_f32_32x32x16_bf16 v[32:47], v[140:143], v[124:127], v[32:47]
  v_mfma_f32_32x32x16_bf16 v[80:95], v[140:143], v[128:131], v[80:95]
  s_waitcnt lgkmcnt(0)
  v_mfma_f32_32x32x16_bf16 v[0:15], v[104:107], v[96:99], v[0:15]
  ds_read_b128 v[124:127], v189 offset:4096
  ds_read_b64_tr_b16 v[132:133], v168 offset:52736
  ds_read_b64_tr_b16 v[134:135], v168 offset:53504
  v_mfma_f32_32x32x16_bf16 v[48:63], v[104:107], v[100:103], v[48:63]
  ds_read_b128 v[128:131], v189 offset:16384
  ds_read_b64_tr_b16 v[136:137], v168 offset:52864
  ds_read_b64_tr_b16 v[138:139], v168 offset:53632
  v_mfma_f32_32x32x16_bf16 v[16:31], v[108:111], v[96:99], v[16:31]
  ds_read_b64_tr_b16 v[140:141], v168 offset:52992
  ds_read_b64_tr_b16 v[142:143], v168 offset:53760
  s_add_u32 m0, s25, 37248
  s_mov_b32 s31, 1990656
  s_mov_b32 exec_hi, 65535
  buffer_load_dwordx4 v165, s[12:15], s31 offen lds
  s_mov_b32 exec_hi, -1
  v_mfma_f32_32x32x16_bf16 v[64:79], v[108:111], v[100:103], v[64:79]
  s_add_u32 m0, s25, 43520
  s_mov_b32 s31, 1990656
  s_mov_b32 exec_hi, 65535
  buffer_load_dwordx4 v165, s[16:19], s31 offen lds
  s_mov_b32 exec_hi, -1
  v_mfma_f32_32x32x16_bf16 v[32:47], v[112:115], v[96:99], v[32:47]
  v_mfma_f32_32x32x16_bf16 v[80:95], v[112:115], v[100:103], v[80:95]
  s_waitcnt vmcnt(13) lgkmcnt(0)
  s_barrier
  v_mfma_f32_32x32x16_bf16 v[0:15], v[132:135], v[124:127], v[0:15]
  ds_read_b128 v[96:99], v190 offset:4096
  ds_read_b64_tr_b16 v[104:105], v168 offset:0
  ds_read_b64_tr_b16 v[106:107], v168 offset:768
  v_mfma_f32_32x32x16_bf16 v[48:63], v[132:135], v[128:131], v[48:63]
  ds_read_b128 v[100:103], v190 offset:16384
  ds_read_b64_tr_b16 v[108:109], v168 offset:128
  ds_read_b64_tr_b16 v[110:111], v168 offset:896
  v_mfma_f32_32x32x16_bf16 v[16:31], v[136:139], v[124:127], v[16:31]
  ds_read_b64_tr_b16 v[112:113], v168 offset:256
  ds_read_b64_tr_b16 v[114:115], v168 offset:1024
  s_cmp_lg_u32 s20, 0
  s_cbranch_scc1 FPG_done
  v_and_b32 v192, 7, v207
  s_and_b32 s26, s72, 31
  v_lshl_add_u32 v192, v192, 5, s26
  s_and_b32 s26, s72, 0xe0
  v_add_u32 v193, s26, v207
  v_cmp_gt_u32 vcc, 32, v207
  s_nop 1
  v_cndmask_b32 v192, v192, v193, vcc

  v_lshlrev_b32 v192, 7, v192
  s_mov_b32 s26, 0x100000
  s_mov_b32 s83, 16384
FPG_loop:
  buffer_load_dword v193, v192, s[64:67], s83 offen sc1
  s_sub_u32 s26, s26, 1
  s_cbranch_scc1 FPG_done
  s_waitcnt vmcnt(0)
  v_cmp_ne_u32 vcc, s82, v193
  s_cbranch_vccz FPG_done
  s_sleep 1
  s_branch FPG_loop
FPG_done:
  v_mfma_f32_32x32x16_bf16 v[64:79], v[136:139], v[128:131], v[64:79]
  s_add_u32 m0, s24, 2048
  s_movk_i32 s30, 1152
  buffer_load_dwordx4 v186, s[8:11], s30 offen lds
  v_mfma_f32_32x32x16_bf16 v[32:47], v[140:143], v[124:127], v[32:47]
  s_add_u32 m0, s24, 3072
  s_movk_i32 s30, 1152
  buffer_load_dwordx4 v187, s[8:11], s30 offen lds
  v_mfma_f32_32x32x16_bf16 v[80:95], v[140:143], v[128:131], v[80:95]
  s_waitcnt lgkmcnt(0)
  v_mfma_f32_32x32x16_bf16 v[0:15], v[104:107], v[96:99], v[0:15]
  ds_read_b128 v[124:127], v191 offset:4096
  ds_read_b64_tr_b16 v[132:133], v168 offset:3072
  ds_read_b64_tr_b16 v[134:135], v168 offset:3840
  v_mfma_f32_32x32x16_bf16 v[48:63], v[104:107], v[100:103], v[48:63]
  ds_read_b128 v[128:131], v191 offset:16384
  ds_read_b64_tr_b16 v[136:137], v168 offset:3200
  ds_read_b64_tr_b16 v[138:139], v168 offset:3968
  v_mfma_f32_32x32x16_bf16 v[16:31], v[108:111], v[96:99], v[16:31]
  ds_read_b64_tr_b16 v[140:141], v168 offset:3328
  ds_read_b64_tr_b16 v[142:143], v168 offset:4096
  s_add_u32 m0, s25, 49664
  s_mov_b32 s31, 2101248
  s_mov_b32 exec_hi, 65535
  buffer_load_dwordx4 v165, s[12:15], s31 offen lds
  s_mov_b32 exec_hi, -1
  v_mfma_f32_32x32x16_bf16 v[64:79], v[108:111], v[100:103], v[64:79]
  s_add_u32 m0, s25, 55936
  s_mov_b32 s31, 2101248
  s_mov_b32 exec_hi, 65535
  buffer_load_dwordx4 v165, s[16:19], s31 offen lds
  s_mov_b32 exec_hi, -1
  v_mfma_f32_32x32x16_bf16 v[32:47], v[112:115], v[96:99], v[32:47]
  v_mfma_f32_32x32x16_bf16 v[80:95], v[112:115], v[100:103], v[80:95]
  s_waitcnt vmcnt(10) lgkmcnt(0)
  s_barrier
  v_mfma_f32_32x32x16_bf16 v[0:15], v[132:135], v[124:127], v[0:15]
  ds_read_b128 v[96:99], v188 offset:8192
  ds_read_b64_tr_b16 v[104:105], v168 offset:12416
  ds_read_b64_tr_b16 v[106:107], v168 offset:13184
  v_mfma_f32_32x32x16_bf16 v[48:63], v[132:135], v[128:131], v[48:63]
  ds_read_b128 v[100:103], v188 offset:20480
  ds_read_b64_tr_b16 v[108:109], v168 offset:12544
  ds_read_b64_tr_b16 v[110:111], v168 offset:13312
  v_mfma_f32_32x32x16_bf16 v[16:31], v[136:139], v[124:127], v[16:31]
  ds_read_b64_tr_b16 v[112:113], v168 offset:12672
  ds_read_b64_tr_b16 v[114:115], v168 offset:13440
  v_and_b32 v192, 31, v207
  v_add_u32 v192, s59, v192
  v_lshlrev_b32 v192, 3, v192
  s_mul_i32 s33, s58, 6144
  s_add_u32 s33, s33, 114688
  s_add_u32 s34, s33, 3072
  v_lshl_add_u32 v193, s20, 6, v207
  v_cmp_gt_u32 vcc, 192, v193
  v_lshlrev_b32 v193, 2, v193
  v_mov_b32 v194, 0x40000000
  v_add_u32 v169, 160384, v193
  v_mov_b32 v195, 163456
  v_cndmask_b32 v193, v194, v193, vcc
  v_cndmask_b32 v169, v195, v169, vcc
  v_mfma_f32_32x32x16_bf16 v[64:79], v[136:139], v[128:131], v[64:79]
  buffer_load_dwordx2 v[208:209], v192, s[64:67], 0 offen offset:0 sc1
  v_mfma_f32_32x32x16_bf16 v[32:47], v[140:143], v[124:127], v[32:47]
  buffer_load_dwordx2 v[212:213], v192, s[64:67], 0 offen offset:256 sc1
  v_mfma_f32_32x32x16_bf16 v[80:95], v[140:143], v[128:131], v[80:95]
  s_waitcnt lgkmcnt(0)
  v_mfma_f32_32x32x16_bf16 v[0:15], v[104:107], v[96:99], v[0:15]
  ds_read_b128 v[124:127], v189 offset:8192
  ds_read_b64_tr_b16 v[132:133], v168 offset:15488
  ds_read_b64_tr_b16 v[134:135], v168 offset:16256
  v_mfma_f32_32x32x16_bf16 v[48:63], v[104:107], v[100:103], v[48:63]
  ds_read_b128 v[128:131], v189 offset:20480
  ds_read_b64_tr_b16 v[136:137], v168 offset:15616
  ds_read_b64_tr_b16 v[138:139], v168 offset:16384
  v_mfma_f32_32x32x16_bf16 v[16:31], v[108:111], v[96:99], v[16:31]
  ds_read_b64_tr_b16 v[140:141], v168 offset:15744
  ds_read_b64_tr_b16 v[142:143], v168 offset:16512
  buffer_load_dword v216, v193, s[64:67], s33 offen offset:0 sc1
  buffer_load_dword v217, v193, s[64:67], s33 offen offset:768 sc1
  v_mfma_f32_32x32x16_bf16 v[64:79], v[108:111], v[100:103], v[64:79]
  buffer_load_dword v218, v193, s[64:67], s33 offen offset:1536 sc1
  buffer_load_dword v219, v193, s[64:67], s33 offen offset:2304 sc1
  v_mfma_f32_32x32x16_bf16 v[32:47], v[112:115], v[96:99], v[32:47]
  buffer_load_dword v220, v193, s[64:67], s34 offen offset:0 sc1
  buffer_load_dword v221, v193, s[64:67], s34 offen offset:768 sc1
  v_mfma_f32_32x32x16_bf16 v[80:95], v[112:115], v[100:103], v[80:95]
  buffer_load_dword v222, v193, s[64:67], s34 offen offset:1536 sc1
  buffer_load_dword v223, v193, s[64:67], s34 offen offset:2304 sc1
  s_waitcnt vmcnt(18) lgkmcnt(0)
  s_barrier
  v_mfma_f32_32x32x16_bf16 v[0:15], v[132:135], v[124:127], v[0:15]
  ds_read_b128 v[96:99], v190 offset:8192
  ds_read_b64_tr_b16 v[104:105], v168 offset:24832
  ds_read_b64_tr_b16 v[106:107], v168 offset:25600
  v_mfma_f32_32x32x16_bf16 v[48:63], v[132:135], v[128:131], v[48:63]
  ds_read_b128 v[100:103], v190 offset:20480
  ds_read_b64_tr_b16 v[108:109], v168 offset:24960
  ds_read_b64_tr_b16 v[110:111], v168 offset:25728
  v_mfma_f32_32x32x16_bf16 v[16:31], v[136:139], v[124:127], v[16:31]
  ds_read_b64_tr_b16 v[112:113], v168 offset:25088
  ds_read_b64_tr_b16 v[114:115], v168 offset:25856
  v_mfma_f32_32x32x16_bf16 v[64:79], v[136:139], v[128:131], v[64:79]
  v_mfma_f32_32x32x16_bf16 v[32:47], v[140:143], v[124:127], v[32:47]
  v_mfma_f32_32x32x16_bf16 v[80:95], v[140:143], v[128:131], v[80:95]
  s_waitcnt lgkmcnt(0)
  v_mfma_f32_32x32x16_bf16 v[0:15], v[104:107], v[96:99], v[0:15]
  ds_read_b128 v[124:127], v191 offset:8192
  ds_read_b64_tr_b16 v[132:133], v168 offset:27904
  ds_read_b64_tr_b16 v[134:135], v168 offset:28672
  v_mfma_f32_32x32x16_bf16 v[48:63], v[104:107], v[100:103], v[48:63]
  ds_read_b128 v[128:131], v191 offset:20480
  ds_read_b64_tr_b16 v[136:137], v168 offset:28032
  ds_read_b64_tr_b16 v[138:139], v168 offset:28800
  v_mfma_f32_32x32x16_bf16 v[16:31], v[108:111], v[96:99], v[16:31]
  ds_read_b64_tr_b16 v[140:141], v168 offset:28160
  ds_read_b64_tr_b16 v[142:143], v168 offset:28928
  v_mfma_f32_32x32x16_bf16 v[64:79], v[108:111], v[100:103], v[64:79]
  v_mfma_f32_32x32x16_bf16 v[32:47], v[112:115], v[96:99], v[32:47]
  v_mfma_f32_32x32x16_bf16 v[80:95], v[112:115], v[100:103], v[80:95]
  s_waitcnt vmcnt(12) lgkmcnt(0)
  s_barrier
  v_mfma_f32_32x32x16_bf16 v[0:15], v[132:135], v[124:127], v[0:15]
  ds_read_b128 v[96:99], v188 offset:0
  ds_read_b64_tr_b16 v[104:105], v168 offset:37248
  ds_read_b64_tr_b16 v[106:107], v168 offset:38016
  v_mfma_f32_32x32x16_bf16 v[48:63], v[132:135], v[128:131], v[48:63]
  ds_read_b128 v[100:103], v188 offset:12288
  ds_read_b64_tr_b16 v[108:109], v168 offset:37376
  ds_read_b64_tr_b16 v[110:111], v168 offset:38144
  v_mfma_f32_32x32x16_bf16 v[16:31], v[136:139], v[124:127], v[16:31]
  ds_read_b64_tr_b16 v[112:113], v168 offset:37504
  ds_read_b64_tr_b16 v[114:115], v168 offset:38272
  v_mfma_f32_32x32x16_bf16 v[64:79], v[136:139], v[128:131], v[64:79]
  v_mfma_f32_32x32x16_bf16 v[32:47], v[140:143], v[124:127], v[32:47]
  v_mfma_f32_32x32x16_bf16 v[80:95], v[140:143], v[128:131], v[80:95]
  s_waitcnt lgkmcnt(0)
  v_mfma_f32_32x32x16_bf16 v[0:15], v[104:107], v[96:99], v[0:15]
  ds_read_b128 v[124:127], v189 offset:0
  ds_read_b64_tr_b16 v[132:133], v168 offset:40320
  ds_read_b64_tr_b16 v[134:135], v168 offset:41088
  v_mfma_f32_32x32x16_bf16 v[48:63], v[104:107], v[100:103], v[48:63]
  ds_read_b128 v[128:131], v189 offset:12288
  ds_read_b64_tr_b16 v[136:137], v168 offset:40448
  ds_read_b64_tr_b16 v[138:139], v168 offset:41216
  v_mfma_f32_32x32x16_bf16 v[16:31], v[108:111], v[96:99], v[16:31]
  ds_read_b64_tr_b16 v[140:141], v168 offset:40576
  ds_read_b64_tr_b16 v[142:143], v168 offset:41344
  v_mfma_f32_32x32x16_bf16 v[64:79], v[108:111], v[100:103], v[64:79]
  v_mfma_f32_32x32x16_bf16 v[32:47], v[112:115], v[96:99], v[32:47]
  v_mfma_f32_32x32x16_bf16 v[80:95], v[112:115], v[100:103], v[80:95]
  s_waitcnt vmcnt(0) lgkmcnt(0)
  s_barrier
  v_mfma_f32_32x32x16_bf16 v[0:15], v[132:135], v[124:127], v[0:15]
  ds_read_b128 v[96:99], v190 offset:0
  ds_read_b64_tr_b16 v[104:105], v168 offset:49664
  ds_read_b64_tr_b16 v[106:107], v168 offset:50432
  v_mfma_f32_32x32x16_bf16 v[48:63], v[132:135], v[128:131], v[48:63]
  ds_read_b128 v[100:103], v190 offset:12288
  ds_read_b64_tr_b16 v[108:109], v168 offset:49792
  ds_read_b64_tr_b16 v[110:111], v168 offset:50560
  v_mfma_f32_32x32x16_bf16 v[16:31], v[136:139], v[124:127], v[16:31]
  ds_read_b64_tr_b16 v[112:113], v168 offset:49920
  ds_read_b64_tr_b16 v[114:115], v168 offset:50688
  v_add_f32 v216, v216, v220
  v_add_f32 v217, v217, v221
  v_add_f32 v218, v218, v222
  v_add_f32 v219, v219, v223
  v_add_f32 v216, v216, v218
  v_add_f32 v217, v217, v219
  v_add_f32 v216, v216, v217
  ds_write_b32 v169, v216
  v_mfma_f32_32x32x16_bf16 v[64:79], v[136:139], v[128:131], v[64:79]
  v_mfma_f32_32x32x16_bf16 v[32:47], v[140:143], v[124:127], v[32:47]
  v_mfma_f32_32x32x16_bf16 v[80:95], v[140:143], v[128:131], v[80:95]
  s_waitcnt lgkmcnt(0)
  v_mfma_f32_32x32x16_bf16 v[0:15], v[104:107], v[96:99], v[0:15]
  ds_read_b128 v[124:127], v191 offset:0
  ds_read_b64_tr_b16 v[132:133], v168 offset:52736
  ds_read_b64_tr_b16 v[134:135], v168 offset:53504
  v_mfma_f32_32x32x16_bf16 v[48:63], v[104:107], v[100:103], v[48:63]
  ds_read_b128 v[128:131], v191 offset:12288
  ds_read_b64_tr_b16 v[136:137], v168 offset:52864
  ds_read_b64_tr_b16 v[138:139], v168 offset:53632
  v_mfma_f32_32x32x16_bf16 v[16:31], v[108:111], v[96:99], v[16:31]
  ds_read_b64_tr_b16 v[140:141], v168 offset:52992
  ds_read_b64_tr_b16 v[142:143], v168 offset:53760
  v_mfma_f32_32x32x16_bf16 v[64:79], v[108:111], v[100:103], v[64:79]
  v_mfma_f32_32x32x16_bf16 v[32:47], v[112:115], v[96:99], v[32:47]
  v_mfma_f32_32x32x16_bf16 v[80:95], v[112:115], v[100:103], v[80:95]
  s_waitcnt lgkmcnt(0)
  v_mfma_f32_32x32x16_bf16 v[0:15], v[132:135], v[124:127], v[0:15]
  v_mfma_f32_32x32x16_bf16 v[48:63], v[132:135], v[128:131], v[48:63]
  v_mfma_f32_32x32x16_bf16 v[16:31], v[136:139], v[124:127], v[16:31]
  v_mfma_f32_32x32x16_bf16 v[64:79], v[136:139], v[128:131], v[64:79]
  v_mfma_f32_32x32x16_bf16 v[32:47], v[140:143], v[124:127], v[32:47]
  v_mfma_f32_32x32x16_bf16 v[80:95], v[140:143], v[128:131], v[80:95]
  v_and_b32 v170, 31, v207
  v_lshrrev_b32 v171, 5, v207
  v_lshlrev_b32 v172, 4, v171
  s_mul_i32 s26, s56, 384
  s_add_u32 s26, s26, 160384
  v_add_u32 v172, s26, v172
  v_add_u32 v170, s59, v170
  s_waitcnt lgkmcnt(0)
  s_barrier

  ds_read_b128 v[96:99], v172 offset:0
  ds_read_b128 v[100:103], v172 offset:32
  ds_read_b128 v[104:107], v172 offset:64
  ds_read_b128 v[108:111], v172 offset:96
  ds_read_b128 v[112:115], v172 offset:128
  ds_read_b128 v[116:119], v172 offset:160
  ds_read_b128 v[120:123], v172 offset:192
  ds_read_b128 v[124:127], v172 offset:224
  ds_read_b128 v[128:131], v172 offset:256
  ds_read_b128 v[132:135], v172 offset:288
  ds_read_b128 v[136:139], v172 offset:320
  ds_read_b128 v[140:143], v172 offset:352
  v_lshrrev_b32 v173, 4, v170
  v_mul_u32_u24 v173, 75776, v173
  v_and_b32 v170, 15, v170
  v_lshl_add_u32 v170, v170, 4, v173
  v_lshl_add_u32 v170, v171, 8, v170
  s_lshl_b32 s26, s22, 5
  s_mul_i32 s3, s56, 1536
  s_add_u32 s26, s26, s3
  s_mov_b32 s33, 151552
  v_add_u32 v170, s26, v170
  s_mov_b32 s34, 0xbdd2d3e8
  v_rcp_f32 v210, v209
  v_rcp_f32 v214, v213
  v_mov_b32 v180, 0xc0135761
  s_waitcnt lgkmcnt(8)
  v_pk_fma_f32 v[0:1], v[96:97], v[208:209], v[0:1] op_sel_hi:[1,0,1]
  v_pk_fma_f32 v[2:3], v[98:99], v[208:209], v[2:3] op_sel_hi:[1,0,1]
  v_pk_fma_f32 v[4:5], v[100:101], v[208:209], v[4:5] op_sel_hi:[1,0,1]
  v_pk_fma_f32 v[6:7], v[102:103], v[208:209], v[6:7] op_sel_hi:[1,0,1]
  v_pk_fma_f32 v[8:9], v[104:105], v[208:209], v[8:9] op_sel_hi:[1,0,1]
  v_pk_fma_f32 v[10:11], v[106:107], v[208:209], v[10:11] op_sel_hi:[1,0,1]
  v_pk_fma_f32 v[12:13], v[108:109], v[208:209], v[12:13] op_sel_hi:[1,0,1]
  v_pk_fma_f32 v[14:15], v[110:111], v[208:209], v[14:15] op_sel_hi:[1,0,1]
  v_pk_mul_f32 v[0:1], v[0:1], v[208:209] op_sel:[0,1] op_sel_hi:[1,1]
  v_pk_mul_f32 v[2:3], v[2:3], v[208:209] op_sel:[0,1] op_sel_hi:[1,1]
  v_pk_mul_f32 v[4:5], v[4:5], v[208:209] op_sel:[0,1] op_sel_hi:[1,1]
  v_pk_mul_f32 v[6:7], v[6:7], v[208:209] op_sel:[0,1] op_sel_hi:[1,1]
  v_pk_mul_f32 v[152:153], v[0:1], v[0:1]
  v_pk_mul_f32 v[154:155], v[2:3], v[2:3]
  v_pk_mul_f32 v[156:157], v[4:5], v[4:5]
  v_pk_mul_f32 v[158:159], v[6:7], v[6:7]
  v_pk_fma_f32 v[152:153], v[152:153], s[34:35], v[180:181] op_sel_hi:[1,0,0]
  v_pk_fma_f32 v[154:155], v[154:155], s[34:35], v[180:181] op_sel_hi:[1,0,0]
  v_pk_fma_f32 v[156:157], v[156:157], s[34:35], v[180:181] op_sel_hi:[1,0,0]
  v_pk_fma_f32 v[158:159], v[158:159], s[34:35], v[180:181] op_sel_hi:[1,0,0]
  v_pk_mul_f32 v[152:153], v[152:153], v[0:1]
  v_pk_mul_f32 v[154:155], v[154:155], v[2:3]
  v_pk_mul_f32 v[156:157], v[156:157], v[4:5]
  v_pk_mul_f32 v[158:159], v[158:159], v[6:7]
  v_exp_f32 v152, v152
  v_exp_f32 v153, v153
  v_exp_f32 v154, v154
  v_exp_f32 v155, v155
  v_exp_f32 v156, v156
  v_exp_f32 v157, v157
  v_exp_f32 v158, v158
  v_exp_f32 v159, v159
  v_pk_mul_f32 v[0:1], v[0:1], v[8:9]
  v_pk_mul_f32 v[2:3], v[2:3], v[10:11]
  v_pk_mul_f32 v[4:5], v[4:5], v[12:13]
  v_pk_mul_f32 v[6:7], v[6:7], v[14:15]
  v_pk_fma_f32 v[152:153], v[152:153], v[210:211], v[210:211] op_sel_hi:[1,0,0]
  v_pk_fma_f32 v[154:155], v[154:155], v[210:211], v[210:211] op_sel_hi:[1,0,0]
  v_pk_fma_f32 v[156:157], v[156:157], v[210:211], v[210:211] op_sel_hi:[1,0,0]
  v_pk_fma_f32 v[158:159], v[158:159], v[210:211], v[210:211] op_sel_hi:[1,0,0]
  v_rcp_f32 v152, v152
  v_rcp_f32 v153, v153
  v_rcp_f32 v154, v154
  v_rcp_f32 v155, v155
  v_rcp_f32 v156, v156
  v_rcp_f32 v157, v157
  v_rcp_f32 v158, v158
  v_rcp_f32 v159, v159
  s_nop 0
  v_pk_mul_f32 v[0:1], v[0:1], v[152:153]
  v_pk_mul_f32 v[2:3], v[2:3], v[154:155]
  v_pk_mul_f32 v[4:5], v[4:5], v[156:157]
  v_pk_mul_f32 v[6:7], v[6:7], v[158:159]
  v_cvt_pk_bf16_f32 v160, v0, v1
  v_cvt_pk_bf16_f32 v161, v2, v3
  v_cvt_pk_bf16_f32 v162, v4, v5
  v_cvt_pk_bf16_f32 v163, v6, v7
  buffer_store_dwordx4 v[160:163], v170, s[4:7], 0 offen offset:0 sc1
  v_pk_fma_f32 v[48:49], v[96:97], v[212:213], v[48:49] op_sel_hi:[1,0,1]
  v_pk_fma_f32 v[50:51], v[98:99], v[212:213], v[50:51] op_sel_hi:[1,0,1]
  v_pk_fma_f32 v[52:53], v[100:101], v[212:213], v[52:53] op_sel_hi:[1,0,1]
  v_pk_fma_f32 v[54:55], v[102:103], v[212:213], v[54:55] op_sel_hi:[1,0,1]
  v_pk_fma_f32 v[56:57], v[104:105], v[212:213], v[56:57] op_sel_hi:[1,0,1]
  v_pk_fma_f32 v[58:59], v[106:107], v[212:213], v[58:59] op_sel_hi:[1,0,1]
  v_pk_fma_f32 v[60:61], v[108:109], v[212:213], v[60:61] op_sel_hi:[1,0,1]
  v_pk_fma_f32 v[62:63], v[110:111], v[212:213], v[62:63] op_sel_hi:[1,0,1]
  v_pk_mul_f32 v[48:49], v[48:49], v[212:213] op_sel:[0,1] op_sel_hi:[1,1]
  v_pk_mul_f32 v[50:51], v[50:51], v[212:213] op_sel:[0,1] op_sel_hi:[1,1]
  v_pk_mul_f32 v[52:53], v[52:53], v[212:213] op_sel:[0,1] op_sel_hi:[1,1]
  v_pk_mul_f32 v[54:55], v[54:55], v[212:213] op_sel:[0,1] op_sel_hi:[1,1]
  v_pk_mul_f32 v[184:185], v[48:49], v[48:49]
  v_pk_mul_f32 v[186:187], v[50:51], v[50:51]
  v_pk_mul_f32 v[188:189], v[52:53], v[52:53]
  v_pk_mul_f32 v[190:191], v[54:55], v[54:55]
  v_pk_fma_f32 v[184:185], v[184:185], s[34:35], v[180:181] op_sel_hi:[1,0,0]
  v_pk_fma_f32 v[186:187], v[186:187], s[34:35], v[180:181] op_sel_hi:[1,0,0]
  v_pk_fma_f32 v[188:189], v[188:189], s[34:35], v[180:181] op_sel_hi:[1,0,0]
  v_pk_fma_f32 v[190:191], v[190:191], s[34:35], v[180:181] op_sel_hi:[1,0,0]
  v_pk_mul_f32 v[184:185], v[184:185], v[48:49]
  v_pk_mul_f32 v[186:187], v[186:187], v[50:51]
  v_pk_mul_f32 v[188:189], v[188:189], v[52:53]
  v_pk_mul_f32 v[190:191], v[190:191], v[54:55]
  v_exp_f32 v184, v184
  v_exp_f32 v185, v185
  v_exp_f32 v186, v186
  v_exp_f32 v187, v187
  v_exp_f32 v188, v188
  v_exp_f32 v189, v189
  v_exp_f32 v190, v190
  v_exp_f32 v191, v191
  v_pk_mul_f32 v[48:49], v[48:49], v[56:57]
  v_pk_mul_f32 v[50:51], v[50:51], v[58:59]
  v_pk_mul_f32 v[52:53], v[52:53], v[60:61]
  v_pk_mul_f32 v[54:55], v[54:55], v[62:63]
  v_pk_fma_f32 v[184:185], v[184:185], v[214:215], v[214:215] op_sel_hi:[1,0,0]
  v_pk_fma_f32 v[186:187], v[186:187], v[214:215], v[214:215] op_sel_hi:[1,0,0]
  v_pk_fma_f32 v[188:189], v[188:189], v[214:215], v[214:215] op_sel_hi:[1,0,0]
  v_pk_fma_f32 v[190:191], v[190:191], v[214:215], v[214:215] op_sel_hi:[1,0,0]
  v_rcp_f32 v184, v184
  v_rcp_f32 v185, v185
  v_rcp_f32 v186, v186
  v_rcp_f32 v187, v187
  v_rcp_f32 v188, v188
  v_rcp_f32 v189, v189
  v_rcp_f32 v190, v190
  v_rcp_f32 v191, v191
  s_nop 0
  v_pk_mul_f32 v[48:49], v[48:49], v[184:185]
  v_pk_mul_f32 v[50:51], v[50:51], v[186:187]
  v_pk_mul_f32 v[52:53], v[52:53], v[188:189]
  v_pk_mul_f32 v[54:55], v[54:55], v[190:191]
  v_cvt_pk_bf16_f32 v192, v48, v49
  v_cvt_pk_bf16_f32 v193, v50, v51
  v_cvt_pk_bf16_f32 v194, v52, v53
  v_cvt_pk_bf16_f32 v195, v54, v55
  buffer_store_dwordx4 v[192:195], v170, s[4:7], s33 offen offset:0 sc1
  s_waitcnt lgkmcnt(4)
  v_pk_fma_f32 v[16:17], v[112:113], v[208:209], v[16:17] op_sel_hi:[1,0,1]
  v_pk_fma_f32 v[18:19], v[114:115], v[208:209], v[18:19] op_sel_hi:[1,0,1]
  v_pk_fma_f32 v[20:21], v[116:117], v[208:209], v[20:21] op_sel_hi:[1,0,1]
  v_pk_fma_f32 v[22:23], v[118:119], v[208:209], v[22:23] op_sel_hi:[1,0,1]
  v_pk_fma_f32 v[24:25], v[120:121], v[208:209], v[24:25] op_sel_hi:[1,0,1]
  v_pk_fma_f32 v[26:27], v[122:123], v[208:209], v[26:27] op_sel_hi:[1,0,1]
  v_pk_fma_f32 v[28:29], v[124:125], v[208:209], v[28:29] op_sel_hi:[1,0,1]
  v_pk_fma_f32 v[30:31], v[126:127], v[208:209], v[30:31] op_sel_hi:[1,0,1]
  v_pk_mul_f32 v[16:17], v[16:17], v[208:209] op_sel:[0,1] op_sel_hi:[1,1]
  v_pk_mul_f32 v[18:19], v[18:19], v[208:209] op_sel:[0,1] op_sel_hi:[1,1]
  v_pk_mul_f32 v[20:21], v[20:21], v[208:209] op_sel:[0,1] op_sel_hi:[1,1]
  v_pk_mul_f32 v[22:23], v[22:23], v[208:209] op_sel:[0,1] op_sel_hi:[1,1]
  v_pk_mul_f32 v[152:153], v[16:17], v[16:17]
  v_pk_mul_f32 v[154:155], v[18:19], v[18:19]
  v_pk_mul_f32 v[156:157], v[20:21], v[20:21]
  v_pk_mul_f32 v[158:159], v[22:23], v[22:23]
  v_pk_fma_f32 v[152:153], v[152:153], s[34:35], v[180:181] op_sel_hi:[1,0,0]
  v_pk_fma_f32 v[154:155], v[154:155], s[34:35], v[180:181] op_sel_hi:[1,0,0]
  v_pk_fma_f32 v[156:157], v[156:157], s[34:35], v[180:181] op_sel_hi:[1,0,0]
  v_pk_fma_f32 v[158:159], v[158:159], s[34:35], v[180:181] op_sel_hi:[1,0,0]
  v_pk_mul_f32 v[152:153], v[152:153], v[16:17]
  v_pk_mul_f32 v[154:155], v[154:155], v[18:19]
  v_pk_mul_f32 v[156:157], v[156:157], v[20:21]
  v_pk_mul_f32 v[158:159], v[158:159], v[22:23]
  v_exp_f32 v152, v152
  v_exp_f32 v153, v153
  v_exp_f32 v154, v154
  v_exp_f32 v155, v155
  v_exp_f32 v156, v156
  v_exp_f32 v157, v157
  v_exp_f32 v158, v158
  v_exp_f32 v159, v159
  v_pk_mul_f32 v[16:17], v[16:17], v[24:25]
  v_pk_mul_f32 v[18:19], v[18:19], v[26:27]
  v_pk_mul_f32 v[20:21], v[20:21], v[28:29]
  v_pk_mul_f32 v[22:23], v[22:23], v[30:31]
  v_pk_fma_f32 v[152:153], v[152:153], v[210:211], v[210:211] op_sel_hi:[1,0,0]
  v_pk_fma_f32 v[154:155], v[154:155], v[210:211], v[210:211] op_sel_hi:[1,0,0]
  v_pk_fma_f32 v[156:157], v[156:157], v[210:211], v[210:211] op_sel_hi:[1,0,0]
  v_pk_fma_f32 v[158:159], v[158:159], v[210:211], v[210:211] op_sel_hi:[1,0,0]
  v_rcp_f32 v152, v152
  v_rcp_f32 v153, v153
  v_rcp_f32 v154, v154
  v_rcp_f32 v155, v155
  v_rcp_f32 v156, v156
  v_rcp_f32 v157, v157
  v_rcp_f32 v158, v158
  v_rcp_f32 v159, v159
  s_nop 0
  v_pk_mul_f32 v[16:17], v[16:17], v[152:153]
  v_pk_mul_f32 v[18:19], v[18:19], v[154:155]
  v_pk_mul_f32 v[20:21], v[20:21], v[156:157]
  v_pk_mul_f32 v[22:23], v[22:23], v[158:159]
  v_cvt_pk_bf16_f32 v160, v16, v17
  v_cvt_pk_bf16_f32 v161, v18, v19
  v_cvt_pk_bf16_f32 v162, v20, v21
  v_cvt_pk_bf16_f32 v163, v22, v23
  buffer_store_dwordx4 v[160:163], v170, s[4:7], 0 offen offset:512 sc1
  v_pk_fma_f32 v[64:65], v[112:113], v[212:213], v[64:65] op_sel_hi:[1,0,1]
  v_pk_fma_f32 v[66:67], v[114:115], v[212:213], v[66:67] op_sel_hi:[1,0,1]
  v_pk_fma_f32 v[68:69], v[116:117], v[212:213], v[68:69] op_sel_hi:[1,0,1]
  v_pk_fma_f32 v[70:71], v[118:119], v[212:213], v[70:71] op_sel_hi:[1,0,1]
  v_pk_fma_f32 v[72:73], v[120:121], v[212:213], v[72:73] op_sel_hi:[1,0,1]
  v_pk_fma_f32 v[74:75], v[122:123], v[212:213], v[74:75] op_sel_hi:[1,0,1]
  v_pk_fma_f32 v[76:77], v[124:125], v[212:213], v[76:77] op_sel_hi:[1,0,1]
  v_pk_fma_f32 v[78:79], v[126:127], v[212:213], v[78:79] op_sel_hi:[1,0,1]
  v_pk_mul_f32 v[64:65], v[64:65], v[212:213] op_sel:[0,1] op_sel_hi:[1,1]
  v_pk_mul_f32 v[66:67], v[66:67], v[212:213] op_sel:[0,1] op_sel_hi:[1,1]
  v_pk_mul_f32 v[68:69], v[68:69], v[212:213] op_sel:[0,1] op_sel_hi:[1,1]
  v_pk_mul_f32 v[70:71], v[70:71], v[212:213] op_sel:[0,1] op_sel_hi:[1,1]
  v_pk_mul_f32 v[184:185], v[64:65], v[64:65]
  v_pk_mul_f32 v[186:187], v[66:67], v[66:67]
  v_pk_mul_f32 v[188:189], v[68:69], v[68:69]
  v_pk_mul_f32 v[190:191], v[70:71], v[70:71]
  v_pk_fma_f32 v[184:185], v[184:185], s[34:35], v[180:181] op_sel_hi:[1,0,0]
  v_pk_fma_f32 v[186:187], v[186:187], s[34:35], v[180:181] op_sel_hi:[1,0,0]
  v_pk_fma_f32 v[188:189], v[188:189], s[34:35], v[180:181] op_sel_hi:[1,0,0]
  v_pk_fma_f32 v[190:191], v[190:191], s[34:35], v[180:181] op_sel_hi:[1,0,0]
  v_pk_mul_f32 v[184:185], v[184:185], v[64:65]
  v_pk_mul_f32 v[186:187], v[186:187], v[66:67]
  v_pk_mul_f32 v[188:189], v[188:189], v[68:69]
  v_pk_mul_f32 v[190:191], v[190:191], v[70:71]
  v_exp_f32 v184, v184
  v_exp_f32 v185, v185
  v_exp_f32 v186, v186
  v_exp_f32 v187, v187
  v_exp_f32 v188, v188
  v_exp_f32 v189, v189
  v_exp_f32 v190, v190
  v_exp_f32 v191, v191
  v_pk_mul_f32 v[64:65], v[64:65], v[72:73]
  v_pk_mul_f32 v[66:67], v[66:67], v[74:75]
  v_pk_mul_f32 v[68:69], v[68:69], v[76:77]
  v_pk_mul_f32 v[70:71], v[70:71], v[78:79]
  v_pk_fma_f32 v[184:185], v[184:185], v[214:215], v[214:215] op_sel_hi:[1,0,0]
  v_pk_fma_f32 v[186:187], v[186:187], v[214:215], v[214:215] op_sel_hi:[1,0,0]
  v_pk_fma_f32 v[188:189], v[188:189], v[214:215], v[214:215] op_sel_hi:[1,0,0]
  v_pk_fma_f32 v[190:191], v[190:191], v[214:215], v[214:215] op_sel_hi:[1,0,0]
  v_rcp_f32 v184, v184
  v_rcp_f32 v185, v185
  v_rcp_f32 v186, v186
  v_rcp_f32 v187, v187
  v_rcp_f32 v188, v188
  v_rcp_f32 v189, v189
  v_rcp_f32 v190, v190
  v_rcp_f32 v191, v191
  s_nop 0
  v_pk_mul_f32 v[64:65], v[64:65], v[184:185]
  v_pk_mul_f32 v[66:67], v[66:67], v[186:187]
  v_pk_mul_f32 v[68:69], v[68:69], v[188:189]
  v_pk_mul_f32 v[70:71], v[70:71], v[190:191]
  v_cvt_pk_bf16_f32 v192, v64, v65
  v_cvt_pk_bf16_f32 v193, v66, v67
  v_cvt_pk_bf16_f32 v194, v68, v69
  v_cvt_pk_bf16_f32 v195, v70, v71
  buffer_store_dwordx4 v[192:195], v170, s[4:7], s33 offen offset:512 sc1
  s_waitcnt lgkmcnt(0)
  v_pk_fma_f32 v[32:33], v[128:129], v[208:209], v[32:33] op_sel_hi:[1,0,1]
  v_pk_fma_f32 v[34:35], v[130:131], v[208:209], v[34:35] op_sel_hi:[1,0,1]
  v_pk_fma_f32 v[36:37], v[132:133], v[208:209], v[36:37] op_sel_hi:[1,0,1]
  v_pk_fma_f32 v[38:39], v[134:135], v[208:209], v[38:39] op_sel_hi:[1,0,1]
  v_pk_fma_f32 v[40:41], v[136:137], v[208:209], v[40:41] op_sel_hi:[1,0,1]
  v_pk_fma_f32 v[42:43], v[138:139], v[208:209], v[42:43] op_sel_hi:[1,0,1]
  v_pk_fma_f32 v[44:45], v[140:141], v[208:209], v[44:45] op_sel_hi:[1,0,1]
  v_pk_fma_f32 v[46:47], v[142:143], v[208:209], v[46:47] op_sel_hi:[1,0,1]
  v_pk_mul_f32 v[32:33], v[32:33], v[208:209] op_sel:[0,1] op_sel_hi:[1,1]
  v_pk_mul_f32 v[34:35], v[34:35], v[208:209] op_sel:[0,1] op_sel_hi:[1,1]
  v_pk_mul_f32 v[36:37], v[36:37], v[208:209] op_sel:[0,1] op_sel_hi:[1,1]
  v_pk_mul_f32 v[38:39], v[38:39], v[208:209] op_sel:[0,1] op_sel_hi:[1,1]
  v_pk_mul_f32 v[152:153], v[32:33], v[32:33]
  v_pk_mul_f32 v[154:155], v[34:35], v[34:35]
  v_pk_mul_f32 v[156:157], v[36:37], v[36:37]
  v_pk_mul_f32 v[158:159], v[38:39], v[38:39]
  v_pk_fma_f32 v[152:153], v[152:153], s[34:35], v[180:181] op_sel_hi:[1,0,0]
  v_pk_fma_f32 v[154:155], v[154:155], s[34:35], v[180:181] op_sel_hi:[1,0,0]
  v_pk_fma_f32 v[156:157], v[156:157], s[34:35], v[180:181] op_sel_hi:[1,0,0]
  v_pk_fma_f32 v[158:159], v[158:159], s[34:35], v[180:181] op_sel_hi:[1,0,0]
  v_pk_mul_f32 v[152:153], v[152:153], v[32:33]
  v_pk_mul_f32 v[154:155], v[154:155], v[34:35]
  v_pk_mul_f32 v[156:157], v[156:157], v[36:37]
  v_pk_mul_f32 v[158:159], v[158:159], v[38:39]
  v_exp_f32 v152, v152
  v_exp_f32 v153, v153
  v_exp_f32 v154, v154
  v_exp_f32 v155, v155
  v_exp_f32 v156, v156
  v_exp_f32 v157, v157
  v_exp_f32 v158, v158
  v_exp_f32 v159, v159
  v_pk_mul_f32 v[32:33], v[32:33], v[40:41]
  v_pk_mul_f32 v[34:35], v[34:35], v[42:43]
  v_pk_mul_f32 v[36:37], v[36:37], v[44:45]
  v_pk_mul_f32 v[38:39], v[38:39], v[46:47]
  v_pk_fma_f32 v[152:153], v[152:153], v[210:211], v[210:211] op_sel_hi:[1,0,0]
  v_pk_fma_f32 v[154:155], v[154:155], v[210:211], v[210:211] op_sel_hi:[1,0,0]
  v_pk_fma_f32 v[156:157], v[156:157], v[210:211], v[210:211] op_sel_hi:[1,0,0]
  v_pk_fma_f32 v[158:159], v[158:159], v[210:211], v[210:211] op_sel_hi:[1,0,0]
  v_rcp_f32 v152, v152
  v_rcp_f32 v153, v153
  v_rcp_f32 v154, v154
  v_rcp_f32 v155, v155
  v_rcp_f32 v156, v156
  v_rcp_f32 v157, v157
  v_rcp_f32 v158, v158
  v_rcp_f32 v159, v159
  s_nop 0
  v_pk_mul_f32 v[32:33], v[32:33], v[152:153]
  v_pk_mul_f32 v[34:35], v[34:35], v[154:155]
  v_pk_mul_f32 v[36:37], v[36:37], v[156:157]
  v_pk_mul_f32 v[38:39], v[38:39], v[158:159]
  v_cvt_pk_bf16_f32 v160, v32, v33
  v_cvt_pk_bf16_f32 v161, v34, v35
  v_cvt_pk_bf16_f32 v162, v36, v37
  v_cvt_pk_bf16_f32 v163, v38, v39
  buffer_store_dwordx4 v[160:163], v170, s[4:7], 0 offen offset:1024 sc1
  v_pk_fma_f32 v[80:81], v[128:129], v[212:213], v[80:81] op_sel_hi:[1,0,1]
  v_pk_fma_f32 v[82:83], v[130:131], v[212:213], v[82:83] op_sel_hi:[1,0,1]
  v_pk_fma_f32 v[84:85], v[132:133], v[212:213], v[84:85] op_sel_hi:[1,0,1]
  v_pk_fma_f32 v[86:87], v[134:135], v[212:213], v[86:87] op_sel_hi:[1,0,1]
  v_pk_fma_f32 v[88:89], v[136:137], v[212:213], v[88:89] op_sel_hi:[1,0,1]
  v_pk_fma_f32 v[90:91], v[138:139], v[212:213], v[90:91] op_sel_hi:[1,0,1]
  v_pk_fma_f32 v[92:93], v[140:141], v[212:213], v[92:93] op_sel_hi:[1,0,1]
  v_pk_fma_f32 v[94:95], v[142:143], v[212:213], v[94:95] op_sel_hi:[1,0,1]
  v_pk_mul_f32 v[80:81], v[80:81], v[212:213] op_sel:[0,1] op_sel_hi:[1,1]
  v_pk_mul_f32 v[82:83], v[82:83], v[212:213] op_sel:[0,1] op_sel_hi:[1,1]
  v_pk_mul_f32 v[84:85], v[84:85], v[212:213] op_sel:[0,1] op_sel_hi:[1,1]
  v_pk_mul_f32 v[86:87], v[86:87], v[212:213] op_sel:[0,1] op_sel_hi:[1,1]
  v_pk_mul_f32 v[184:185], v[80:81], v[80:81]
  v_pk_mul_f32 v[186:187], v[82:83], v[82:83]
  v_pk_mul_f32 v[188:189], v[84:85], v[84:85]
  v_pk_mul_f32 v[190:191], v[86:87], v[86:87]
  v_pk_fma_f32 v[184:185], v[184:185], s[34:35], v[180:181] op_sel_hi:[1,0,0]
  v_pk_fma_f32 v[186:187], v[186:187], s[34:35], v[180:181] op_sel_hi:[1,0,0]
  v_pk_fma_f32 v[188:189], v[188:189], s[34:35], v[180:181] op_sel_hi:[1,0,0]
  v_pk_fma_f32 v[190:191], v[190:191], s[34:35], v[180:181] op_sel_hi:[1,0,0]
  v_pk_mul_f32 v[184:185], v[184:185], v[80:81]
  v_pk_mul_f32 v[186:187], v[186:187], v[82:83]
  v_pk_mul_f32 v[188:189], v[188:189], v[84:85]
  v_pk_mul_f32 v[190:191], v[190:191], v[86:87]
  v_exp_f32 v184, v184
  v_exp_f32 v185, v185
  v_exp_f32 v186, v186
  v_exp_f32 v187, v187
  v_exp_f32 v188, v188
  v_exp_f32 v189, v189
  v_exp_f32 v190, v190
  v_exp_f32 v191, v191
  v_pk_mul_f32 v[80:81], v[80:81], v[88:89]
  v_pk_mul_f32 v[82:83], v[82:83], v[90:91]
  v_pk_mul_f32 v[84:85], v[84:85], v[92:93]
  v_pk_mul_f32 v[86:87], v[86:87], v[94:95]
  v_pk_fma_f32 v[184:185], v[184:185], v[214:215], v[214:215] op_sel_hi:[1,0,0]
  v_pk_fma_f32 v[186:187], v[186:187], v[214:215], v[214:215] op_sel_hi:[1,0,0]
  v_pk_fma_f32 v[188:189], v[188:189], v[214:215], v[214:215] op_sel_hi:[1,0,0]
  v_pk_fma_f32 v[190:191], v[190:191], v[214:215], v[214:215] op_sel_hi:[1,0,0]
  v_rcp_f32 v184, v184
  v_rcp_f32 v185, v185
  v_rcp_f32 v186, v186
  v_rcp_f32 v187, v187
  v_rcp_f32 v188, v188
  v_rcp_f32 v189, v189
  v_rcp_f32 v190, v190
  v_rcp_f32 v191, v191
  s_nop 0
  v_pk_mul_f32 v[80:81], v[80:81], v[184:185]
  v_pk_mul_f32 v[82:83], v[82:83], v[186:187]
  v_pk_mul_f32 v[84:85], v[84:85], v[188:189]
  v_pk_mul_f32 v[86:87], v[86:87], v[190:191]
  v_cvt_pk_bf16_f32 v192, v80, v81
  v_cvt_pk_bf16_f32 v193, v82, v83
  v_cvt_pk_bf16_f32 v194, v84, v85
  v_cvt_pk_bf16_f32 v195, v86, v87
  s_cmp_lt_u32 s20, 4
  s_cbranch_scc1 EP_a
  v_mov_b32 v251, v207
  s_sub_u32 s23, s20, 4
  s_and_b32 s38, s2, 7
  s_lshr_b32 s39, s2, 3
  s_and_b32 s42, s39, 1
  s_lshl_b32 s21, s38, 1
  s_add_u32 s21, s21, s42
  s_lshr_b32 s22, s39, 1
  s_lshr_b32 s38, s21, 2
  v_and_b32 v230, 3, v251
  v_min_u32 v230, 2, v230
  v_lshl_add_u32 v230, v230, 2, s38
  s_mov_b32 s39, 1431655766
  v_mul_hi_u32 v231, v230, s39
  v_mul_u32_u24 v232, 5, v231
  v_add_u32 v230, v230, v232
  s_lshr_b32 s39, s22, 1
  s_sub_u32 s42, s39, 1
  s_max_i32 s42, s42, 0
  s_lshl_b32 s39, s39, 5
  s_lshl_b32 s42, s42, 5
  v_add_u32 v231, s42, v230
  v_add_u32 v230, s39, v230
  v_cmp_gt_u32 vcc, 32, v251
  s_nop 1
  v_cndmask_b32 v230, v231, v230, vcc
  v_lshlrev_b32 v231, 7, v230
  s_mov_b32 s83, 49152
  buffer_load_dword v232, v231, s[64:67], s83 offen sc1
EP_a:
  buffer_store_dwordx4 v[192:195], v170, s[4:7], s33 offen offset:1024 sc1
  s_mov_b32 s44, 0
  s_cmp_lt_u32 s20, 4
  s_cbranch_scc1 EP_b
  s_waitcnt vmcnt(1)
  v_cmp_ne_u32 vcc, s82, v232
  s_cbranch_vccnz EP_b
  s_lshr_b32 s38, s23, 1
  s_and_b32 s39, s23, 1
  s_lshl_b32 s39, s39, 5
  s_lshl_b32 s42, s21, 1
  s_add_u32 s38, s38, s42
  s_add_u32 s38, s38, s39
  s_add_u32 s38, s38, 32
  s_mul_i32 s38, s38, 98304
  s_add_u32 s8, s48, s38
  s_addc_u32 s9, s49, 0
  s_mov_b32 s10, 98304
  s_mov_b32 s11, 0x20000
  s_mul_i32 s38, s42, 98304
  s_add_u32 s12, s48, s38
  s_addc_u32 s13, s49, 0
  s_mov_b32 s14, 196608
  s_mov_b32 s15, 0x20000
  s_mul_i32 s27, s22, 6144
  s_sub_u32 s27, s27, 12288
  s_mul_i32 s28, s23, 18432
  v_lshlrev_b32 v230, 4, v251
  s_mov_b32 s29, 0
ATT_dmab:
  s_cmp_lt_i32 s27, 0
  s_cselect_b32 s30, 0x40000000, s27
  s_mov_b32 m0, s28
  s_add_u32 s27, s27, 3072
  s_add_u32 s28, s28, 3072
  buffer_load_dwordx4 v230, s[8:11], s30 offen sc1 lds
  buffer_load_dwordx4 v230, s[8:11], s30 offen offset:1024 sc1 lds
  buffer_load_dwordx4 v230, s[8:11], s30 offen offset:2048 sc1 lds
  s_add_u32 s29, s29, 1
  s_cmp_lt_u32 s29, 6
  s_cbranch_scc1 ATT_dmab
  s_lshl_b32 s25, s23, 5
  s_lshl_b32 s26, s22, 7
  s_add_u32 s26, s26, s25
  v_and_b32 v231, 31, v251
  v_lshrrev_b32 v232, 5, v251
  v_add_u32 v233, s26, v231
  v_mul_u32_u24 v234, 48, v233
  v_lshlrev_b32 v235, 30, v232
  v_add3_u32 v235, v235, v234, 32
  v_lshl_add_u32 v234, v232, 4, v234
  s_mov_b32 s30, 98304
  buffer_load_dwordx4 v[214:217], v234, s[12:15], 0 offen sc1
  buffer_load_dwordx2 v[218:219], v235, s[12:15], 0 offen sc1
  buffer_load_dwordx4 v[220:223], v234, s[12:15], s30 offen sc1
  buffer_load_dwordx2 v[224:225], v235, s[12:15], s30 offen sc1
  s_mov_b32 s44, 1
EP_b:
  s_branch PHB
K1_pack:
  v_and_b32 v170, 31, v207
  v_lshrrev_b32 v171, 5, v207
  v_bfe_u32 v172, v207, 1, 3
  v_xor_b32 v171, v171, v172
  v_lshlrev_b32 v170, 7, v170
  v_lshl_add_u32 v170, v171, 4, v170
  s_mul_i32 s26, s20, 12288
  v_add_u32 v188, s26, v170
  v_xor_b32 v189, 32, v188
  v_xor_b32 v190, 64, v188
  v_xor_b32 v191, 96, v188
  s_mov_b32 s68, s72
  s_mov_b32 s69, s73
  s_mov_b32 s70, 256
  s_mov_b32 s71, 0x20000
  s_add_u32 s64, s48, 25165824
  s_addc_u32 s65, s49, 0
  s_mov_b32 s66, 299008
  s_mov_b32 s67, 0x20000
  s_lshl_b32 s72, s57, 5
  s_add_u32 s72, s72, s76
  s_lshl_b32 s73, s72, 3
  s_add_u32 s73, s73, s20
  s_load_dwordx2 s[42:43], s[0:1], 16
  s_load_dwordx2 s[44:45], s[0:1], 48
  s_sub_u32 s51, s51, 2
  s_lshl_b32 s51, s51, 3
  s_add_u32 s28, s51, s5
  s_mul_i32 s24, s20, 5120
  v_lshl_add_u32 v170, v207, 4, s24
  v_lshrrev_b32 v171, 4, v207
  v_lshlrev_b32 v171, 3, v171
  v_bfe_u32 v172, v207, 2, 2
  v_add_u32 v171, v171, v172
  v_mul_u32_u24 v171, 1280, v171
  v_and_b32 v172, 3, v207
  v_lshl_add_u32 v171, v172, 3, v171
  s_mul_i32 s3, s20, 160
  v_add_u32 v171, s3, v171
  s_mul_i32 s3, s20, 378880
  v_lshl_add_u32 v172, v207, 4, s3
  v_add_u32 v173, 4096, v170
  v_add_u32 v174, 4096, v172
  s_waitcnt lgkmcnt(0)
  s_add_u32 s4, s48, 20971520
  s_addc_u32 s5, s49, 0
  s_mov_b32 s6, 3031040
  s_mov_b32 s7, 0x20000
  s_add_u32 s27, s28, 0
  s_cmp_ge_u32 s27, 54
  s_cselect_b32 s12, s42, s44
  s_cselect_b32 s13, s43, s45
  s_mov_b32 s14, 2211840
  s_cselect_b32 s14, 819200, s14
  s_mov_b32 s15, 0x20000
  s_cselect_b32 s3, 54, 0
  s_sub_u32 s3, s27, s3
  s_add_u32 m0, s24, 0
  s_mul_i32 s31, s3, 40960
  buffer_load_dwordx4 v170, s[12:15], s31 offen offset:0 lds
  buffer_load_dwordx4 v170, s[12:15], s31 offen offset:1024 lds
  buffer_load_dwordx4 v170, s[12:15], s31 offen offset:2048 lds
  buffer_load_dwordx4 v170, s[12:15], s31 offen offset:3072 lds
  s_add_u32 m0, s24, 4096
  s_nop 0
  buffer_load_dwordx4 v173, s[12:15], s31 offen lds
  s_add_u32 s27, s28, 16
  s_cmp_ge_u32 s27, 54
  s_cselect_b32 s12, s42, s44
  s_cselect_b32 s13, s43, s45
  s_mov_b32 s14, 2211840
  s_cselect_b32 s14, 819200, s14
  s_mov_b32 s15, 0x20000
  s_cselect_b32 s3, 54, 0
  s_sub_u32 s3, s27, s3
  s_add_u32 m0, s24, 40960
  s_mul_i32 s31, s3, 40960
  buffer_load_dwordx4 v170, s[12:15], s31 offen offset:0 lds
  buffer_load_dwordx4 v170, s[12:15], s31 offen offset:1024 lds
  buffer_load_dwordx4 v170, s[12:15], s31 offen offset:2048 lds
  buffer_load_dwordx4 v170, s[12:15], s31 offen offset:3072 lds
  s_add_u32 m0, s24, 45056
  s_nop 0
  buffer_load_dwordx4 v173, s[12:15], s31 offen lds
  s_add_u32 s27, s28, 32
  s_cmp_ge_u32 s27, 54
  s_cselect_b32 s12, s42, s44
  s_cselect_b32 s13, s43, s45
  s_mov_b32 s14, 2211840
  s_cselect_b32 s14, 819200, s14
  s_mov_b32 s15, 0x20000
  s_cselect_b32 s3, 54, 0
  s_sub_u32 s3, s27, s3
  s_add_u32 m0, s24, 81920
  s_mul_i32 s31, s3, 40960
  buffer_load_dwordx4 v170, s[12:15], s31 offen offset:0 lds
  buffer_load_dwordx4 v170, s[12:15], s31 offen offset:1024 lds
  buffer_load_dwordx4 v170, s[12:15], s31 offen offset:2048 lds
  buffer_load_dwordx4 v170, s[12:15], s31 offen offset:3072 lds
  s_add_u32 m0, s24, 86016
  s_nop 0
  buffer_load_dwordx4 v173, s[12:15], s31 offen lds
  s_mul_i32 s26, s73, 1280
  v_mul_u32_u24 v157, 20, v207
  buffer_load_dwordx4 v[152:155], v157, s[8:11], s26 offen
  buffer_load_dword v156, v157, s[8:11], s26 offen offset:16
  s_waitcnt vmcnt(0)
  v_lshlrev_b32 v192, 16, v152
  v_and_b32 v193, s32, v152
  v_add_f32 v158, v192, v193
  v_mul_f32 v159, v192, v192
  v_fmac_f32 v159, v193, v193
  v_lshlrev_b32 v192, 16, v153
  v_and_b32 v193, s32, v153
  v_add_f32 v158, v158, v192
  v_fmac_f32 v159, v192, v192
  v_add_f32 v158, v158, v193
  v_fmac_f32 v159, v193, v193
  v_lshlrev_b32 v192, 16, v154
  v_and_b32 v193, s32, v154
  v_add_f32 v158, v158, v192
  v_fmac_f32 v159, v192, v192
  v_add_f32 v158, v158, v193
  v_fmac_f32 v159, v193, v193
  v_lshlrev_b32 v192, 16, v155
  v_and_b32 v193, s32, v155
  v_add_f32 v158, v158, v192
  v_fmac_f32 v159, v192, v192
  v_add_f32 v158, v158, v193
  v_fmac_f32 v159, v193, v193
  v_lshlrev_b32 v192, 16, v156
  v_and_b32 v193, s32, v156
  v_add_f32 v158, v158, v192
  v_fmac_f32 v159, v192, v192
  v_add_f32 v158, v158, v193
  v_fmac_f32 v159, v193, v193
  s_nop 1
  v_add_f32_dpp v158, v158, v158 row_shr:1 bound_ctrl:0
  v_add_f32_dpp v159, v159, v159 row_shr:1 bound_ctrl:0
  s_nop 1
  v_add_f32_dpp v158, v158, v158 row_shr:2 bound_ctrl:0
  v_add_f32_dpp v159, v159, v159 row_shr:2 bound_ctrl:0
  s_nop 1
  v_add_f32_dpp v158, v158, v158 row_shr:4 bound_ctrl:0
  v_add_f32_dpp v159, v159, v159 row_shr:4 bound_ctrl:0
  s_nop 1
  v_add_f32_dpp v158, v158, v158 row_shr:8 bound_ctrl:0
  v_add_f32_dpp v159, v159, v159 row_shr:8 bound_ctrl:0
  s_nop 1
  v_add_f32_dpp v158, v158, v158 row_bcast:15 row_mask:0xa
  v_add_f32_dpp v159, v159, v159 row_bcast:15 row_mask:0xa
  s_nop 1
  v_add_f32_dpp v158, v158, v158 row_bcast:31 row_mask:0xc
  v_add_f32_dpp v159, v159, v159 row_bcast:31 row_mask:0xc
  v_mul_f32 v158, 0xbacccccd, v158
  v_mul_f32 v159, 0x3acccccd, v159
  v_fma_f32 v159, -v158, v158, v159
  v_max_f32 v159, 0, v159
  v_add_f32 v159, 0x3727c5ac, v159
  v_rsq_f32 v159, v159
  v_cmp_eq_u32 vcc, 63, v207
  v_mov_b32 v192, 0x40000000
  s_lshl_b32 s26, s73, 3
  v_cndmask_b32 v192, v192, 0, vcc
  buffer_store_dwordx2 v[158:159], v192, s[64:67], s26 offen sc1
  v_mov_b32 v192, 0
  s_mov_b32 s26, 0x100000
NGP_loop:
  buffer_load_dword v193, v192, s[68:71], 0 offen sc1
  s_sub_u32 s26, s26, 1
  s_cbranch_scc1 NGP_done
  s_waitcnt vmcnt(0)
  v_readfirstlane_b32 s82, v193
  s_cmp_eq_u32 s82, 0
  s_cbranch_scc1 NGP_loop
NGP_done:
  s_waitcnt vmcnt(0)
  s_barrier
  v_cmp_eq_u32 vcc, 0, v207
  v_mov_b32 v192, 0x40000000
  s_lshl_b32 s26, s72, 7
  s_add_u32 s26, s26, 16384
  s_cmp_eq_u32 s20, 0
  s_cselect_b32 s26, s26, 0x40000000
  v_mov_b32 v193, s82
  v_cndmask_b32 v192, v192, 0, vcc
  buffer_store_dword v193, v192, s[64:67], s26 offen sc1
  v_add_u32 v175, 81920, v171
  ds_read_b64_tr_b16 v[0:1], v171 offset:0
  ds_read_b64_tr_b16 v[2:3], v171 offset:5120
  ds_read_b64_tr_b16 v[4:5], v171 offset:32
  ds_read_b64_tr_b16 v[6:7], v171 offset:5152
  ds_read_b64_tr_b16 v[8:9], v171 offset:64
  ds_read_b64_tr_b16 v[10:11], v171 offset:5184
  ds_read_b64_tr_b16 v[12:13], v171 offset:96
  ds_read_b64_tr_b16 v[14:15], v171 offset:5216
  ds_read_b64_tr_b16 v[16:17], v171 offset:128
  ds_read_b64_tr_b16 v[18:19], v171 offset:5248
  s_waitcnt lgkmcnt(0)
  s_barrier
  s_add_u32 s27, s28, 48
  s_cmp_ge_u32 s27, 54
  s_cselect_b32 s12, s42, s44
  s_cselect_b32 s13, s43, s45
  s_mov_b32 s14, 2211840
  s_cselect_b32 s14, 819200, s14
  s_mov_b32 s15, 0x20000
  s_cselect_b32 s3, 54, 0
  s_sub_u32 s3, s27, s3
  s_add_u32 m0, s24, 0
  s_mul_i32 s31, s3, 40960
  buffer_load_dwordx4 v170, s[12:15], s31 offen offset:0 lds
  buffer_load_dwordx4 v170, s[12:15], s31 offen offset:1024 lds
  buffer_load_dwordx4 v170, s[12:15], s31 offen offset:2048 lds
  buffer_load_dwordx4 v170, s[12:15], s31 offen offset:3072 lds
  s_add_u32 m0, s24, 4096
  s_nop 0
  buffer_load_dwordx4 v173, s[12:15], s31 offen lds
  s_add_u32 s27, s28, 0
  s_mul_i32 s30, s27, 5120
  s_cmp_lt_u32 s27, 74
  s_cselect_b32 s30, s30, 0x40000000
  buffer_store_dwordx4 v[0:3], v172, s[4:7], s30 offen offset:0 sc1
  buffer_store_dwordx4 v[4:7], v172, s[4:7], s30 offen offset:1024 sc1
  buffer_store_dwordx4 v[8:11], v172, s[4:7], s30 offen offset:2048 sc1
  buffer_store_dwordx4 v[12:15], v172, s[4:7], s30 offen offset:3072 sc1
  buffer_store_dwordx4 v[16:19], v174, s[4:7], s30 offen sc1
  ds_read_b64_tr_b16 v[20:21], v171 offset:40960
  ds_read_b64_tr_b16 v[22:23], v171 offset:46080
  ds_read_b64_tr_b16 v[24:25], v171 offset:40992
  ds_read_b64_tr_b16 v[26:27], v171 offset:46112
  ds_read_b64_tr_b16 v[28:29], v171 offset:41024
  ds_read_b64_tr_b16 v[30:31], v171 offset:46144
  ds_read_b64_tr_b16 v[32:33], v171 offset:41056
  ds_read_b64_tr_b16 v[34:35], v171 offset:46176
  ds_read_b64_tr_b16 v[36:37], v171 offset:41088
  ds_read_b64_tr_b16 v[38:39], v171 offset:46208
  s_waitcnt lgkmcnt(0)
  s_barrier
  s_add_u32 s27, s28, 64
  s_cmp_ge_u32 s27, 54
  s_cselect_b32 s12, s42, s44
  s_cselect_b32 s13, s43, s45
  s_mov_b32 s14, 2211840
  s_cselect_b32 s14, 819200, s14
  s_mov_b32 s15, 0x20000
  s_cselect_b32 s3, 54, 0
  s_sub_u32 s3, s27, s3
  s_add_u32 m0, s24, 40960
  s_mul_i32 s31, s3, 40960
  buffer_load_dwordx4 v170, s[12:15], s31 offen offset:0 lds
  buffer_load_dwordx4 v170, s[12:15], s31 offen offset:1024 lds
  buffer_load_dwordx4 v170, s[12:15], s31 offen offset:2048 lds
  buffer_load_dwordx4 v170, s[12:15], s31 offen offset:3072 lds
  s_add_u32 m0, s24, 45056
  s_nop 0
  buffer_load_dwordx4 v173, s[12:15], s31 offen lds
  s_add_u32 s27, s28, 16
  s_mul_i32 s30, s27, 5120
  s_cmp_lt_u32 s27, 74
  s_cselect_b32 s30, s30, 0x40000000
  buffer_store_dwordx4 v[20:23], v172, s[4:7], s30 offen offset:0 sc1
  buffer_store_dwordx4 v[24:27], v172, s[4:7], s30 offen offset:1024 sc1
  buffer_store_dwordx4 v[28:31], v172, s[4:7], s30 offen offset:2048 sc1
  buffer_store_dwordx4 v[32:35], v172, s[4:7], s30 offen offset:3072 sc1
  buffer_store_dwordx4 v[36:39], v174, s[4:7], s30 offen sc1
  ds_read_b64_tr_b16 v[0:1], v175 offset:0
  ds_read_b64_tr_b16 v[2:3], v175 offset:5120
  ds_read_b64_tr_b16 v[4:5], v175 offset:32
  ds_read_b64_tr_b16 v[6:7], v175 offset:5152
  ds_read_b64_tr_b16 v[8:9], v175 offset:64
  ds_read_b64_tr_b16 v[10:11], v175 offset:5184
  ds_read_b64_tr_b16 v[12:13], v175 offset:96
  ds_read_b64_tr_b16 v[14:15], v175 offset:5216
  ds_read_b64_tr_b16 v[16:17], v175 offset:128
  ds_read_b64_tr_b16 v[18:19], v175 offset:5248
  s_waitcnt lgkmcnt(0)
  s_add_u32 s27, s28, 32
  s_mul_i32 s30, s27, 5120
  s_cmp_lt_u32 s27, 74
  s_cselect_b32 s30, s30, 0x40000000
  buffer_store_dwordx4 v[0:3], v172, s[4:7], s30 offen offset:0 sc1
  buffer_store_dwordx4 v[4:7], v172, s[4:7], s30 offen offset:1024 sc1
  buffer_store_dwordx4 v[8:11], v172, s[4:7], s30 offen offset:2048 sc1
  buffer_store_dwordx4 v[12:15], v172, s[4:7], s30 offen offset:3072 sc1
  buffer_store_dwordx4 v[16:19], v174, s[4:7], s30 offen sc1
  s_waitcnt vmcnt(15)
  s_barrier
  ds_read_b64_tr_b16 v[20:21], v171 offset:0
  ds_read_b64_tr_b16 v[22:23], v171 offset:5120
  ds_read_b64_tr_b16 v[24:25], v171 offset:32
  ds_read_b64_tr_b16 v[26:27], v171 offset:5152
  ds_read_b64_tr_b16 v[28:29], v171 offset:64
  ds_read_b64_tr_b16 v[30:31], v171 offset:5184
  ds_read_b64_tr_b16 v[32:33], v171 offset:96
  ds_read_b64_tr_b16 v[34:35], v171 offset:5216
  ds_read_b64_tr_b16 v[36:37], v171 offset:128
  ds_read_b64_tr_b16 v[38:39], v171 offset:5248
  s_waitcnt lgkmcnt(0)
  s_add_u32 s27, s28, 48
  s_mul_i32 s30, s27, 5120
  s_cmp_lt_u32 s27, 74
  s_cselect_b32 s30, s30, 0x40000000
  buffer_store_dwordx4 v[20:23], v172, s[4:7], s30 offen offset:0 sc1
  buffer_store_dwordx4 v[24:27], v172, s[4:7], s30 offen offset:1024 sc1
  buffer_store_dwordx4 v[28:31], v172, s[4:7], s30 offen offset:2048 sc1
  buffer_store_dwordx4 v[32:35], v172, s[4:7], s30 offen offset:3072 sc1
  buffer_store_dwordx4 v[36:39], v174, s[4:7], s30 offen sc1
  s_waitcnt vmcnt(10)
  s_barrier
  ds_read_b64_tr_b16 v[0:1], v171 offset:40960
  ds_read_b64_tr_b16 v[2:3], v171 offset:46080
  ds_read_b64_tr_b16 v[4:5], v171 offset:40992
  ds_read_b64_tr_b16 v[6:7], v171 offset:46112
  ds_read_b64_tr_b16 v[8:9], v171 offset:41024
  ds_read_b64_tr_b16 v[10:11], v171 offset:46144
  ds_read_b64_tr_b16 v[12:13], v171 offset:41056
  ds_read_b64_tr_b16 v[14:15], v171 offset:46176
  ds_read_b64_tr_b16 v[16:17], v171 offset:41088
  ds_read_b64_tr_b16 v[18:19], v171 offset:46208
  s_waitcnt lgkmcnt(0)
  s_add_u32 s27, s28, 64
  s_mul_i32 s30, s27, 5120
  s_cmp_lt_u32 s27, 74
  s_cselect_b32 s30, s30, 0x40000000
  buffer_store_dwordx4 v[0:3], v172, s[4:7], s30 offen offset:0 sc1
  buffer_store_dwordx4 v[4:7], v172, s[4:7], s30 offen offset:1024 sc1
  buffer_store_dwordx4 v[8:11], v172, s[4:7], s30 offen offset:2048 sc1
  buffer_store_dwordx4 v[12:15], v172, s[4:7], s30 offen offset:3072 sc1
  buffer_store_dwordx4 v[16:19], v174, s[4:7], s30 offen sc1
  s_mov_b32 s44, 2
PHB:
  s_load_dwordx2 s[46:47], s[0:1], 56
  v_mov_b32 v251, v207
  v_mov_b32 v240, 73728
  v_mov_b32 v242, 0
  v_mov_b32 v243, 0
  s_and_b32 s3, s2, 7
  s_lshr_b32 s4, s2, 3
  s_lshr_b32 s5, s3, 1
  s_lshl_b32 s5, s5, 3
  s_and_b32 s6, s4, 7
  s_add_u32 s50, s5, s6
  s_and_b32 s3, s3, 1
  s_lshl_b32 s3, s3, 2
  s_lshr_b32 s4, s4, 3
  s_add_u32 s51, s3, s4
  s_cmp_eq_u32 s44, 1
  s_cbranch_scc1 PHB_e
  s_waitcnt vmcnt(0)
PHB_e:
  s_waitcnt vmcnt(22) lgkmcnt(0)
  s_barrier
  ds_write_b64 v240, v[242:243]
  ds_write_b32 v240, v242 offset:8
  v_cmp_eq_u32 vcc, 0, v251
  v_mov_b32 v244, 0x40000000
  s_lshl_b32 s26, s72, 7
  s_add_u32 s26, s26, 49152
  s_cmp_eq_u32 s20, 0
  s_cselect_b32 s26, s26, 0x40000000
  v_mov_b32 v245, s82
  v_cndmask_b32 v244, v244, 0, vcc
  buffer_store_dword v245, v244, s[64:67], s26 offen sc1
  s_waitcnt lgkmcnt(0)
  s_barrier
  s_cmp_ge_u32 s20, 4
  s_cbranch_scc1 ATT
  s_lshr_b32 s3, s50, 2
  s_lshl_b32 s3, s3, 5
  v_add_u32 v240, s3, v251
  v_and_b32 v241, 7, v251
  v_lshlrev_b32 v241, 5, v241
  v_and_b32 v242, 8, v251
  v_add3_u32 v241, v241, v242, 23
  v_cmp_gt_u32 vcc, 32, v251
  s_lshl_b32 s21, s50, 6
  s_mul_i32 s22, s51, 160
  v_cndmask_b32 v240, v241, v240, vcc
  s_mul_i32 s27, s20, 14
  s_cmp_eq_u32 s20, 3
  s_cselect_b32 s27, 41, s27
  s_mul_i32 s5, s50, 303104
  s_mul_i32 s3, s51, 378880
  v_lshl_add_u32 v234, v251, 4, s5
  v_add_u32 v235, 75776, v234
  v_add_u32 v236, 151552, v234
  v_add_u32 v237, 227328, v234
  v_lshl_add_u32 v238, v251, 4, s3
  v_add_u32 v239, 4096, v238
  s_lshl_b32 s30, s27, 10
  s_mul_i32 s31, s27, 5120
  v_and_b32 v245, 15, v251
  v_lshrrev_b32 v244, 4, v251
  s_lshl_b32 s3, s20, 4
  s_add_u32 s3, s3, s21
  v_add_u32 v245, s3, v245
  v_mul_u32_u24 v245, 1280, v245
  v_lshl_add_u32 v245, v244, 3, v245
  v_add_u32 v248, s22, v245
  s_mov_b32 s4, s40
  s_mov_b32 s5, s41
  s_mov_b32 s6, 2621440
  s_mov_b32 s7, 0x20000
  s_add_u32 s8, s48, 9437184
  s_addc_u32 s9, s49, 0
  s_mov_b32 s10, 9699328
  s_mov_b32 s11, 0x20000
  s_add_u32 s12, s48, 20971520
  s_addc_u32 s13, s49, 0
  s_mov_b32 s14, 3031040
  s_mov_b32 s15, 0x20000
  s_mov_b32 s16, s46
  s_mov_b32 s17, s47
  s_mov_b32 s18, 2621440
  s_mov_b32 s19, 0x20000
  buffer_load_dwordx2 v[224:225], v248, s[4:7], 0 offen offset:0
  buffer_load_dwordx2 v[226:227], v248, s[4:7], 0 offen offset:32
  buffer_load_dwordx2 v[228:229], v248, s[4:7], 0 offen offset:64
  buffer_load_dwordx2 v[230:231], v248, s[4:7], 0 offen offset:96
  buffer_load_dwordx2 v[232:233], v248, s[4:7], 0 offen offset:128
  v_mov_b32 v246, 73728
KV_sp:
  ds_read_b32 v247, v246
  s_waitcnt lgkmcnt(0)
  v_readfirstlane_b32 s3, v247
  s_cmp_ge_u32 s3, 4
  s_cbranch_scc1 KV_dn
  s_sleep 1
  s_branch KV_sp
KV_dn:
  v_mov_b32 v246, v241
  v_lshlrev_b32 v246, 7, v246
  s_mov_b32 s26, 0x100000
  s_mov_b32 s83, 49152
FPP2_loop:
  buffer_load_dword v247, v246, s[64:67], s83 offen sc1
  s_sub_u32 s26, s26, 1
  s_cbranch_scc1 FPP2_done
  s_waitcnt vmcnt(0)
  v_cmp_ne_u32 vcc, s82, v247
  s_cbranch_vccz FPP2_done
  s_sleep 1
  s_branch FPP2_loop
FPP2_done:
  s_mul_i32 s24, s20, 20480
  s_add_u32 s24, s24, 81920
  v_lshl_add_u32 v247, v251, 4, s24
  s_add_u32 m0, s24, 0
  s_nop 0
  buffer_load_dwordx4 v238, s[12:15], s31 offen offset:0 sc1 lds
  buffer_load_dwordx4 v238, s[12:15], s31 offen offset:1024 sc1 lds
  buffer_load_dwordx4 v238, s[12:15], s31 offen offset:2048 sc1 lds
  buffer_load_dwordx4 v238, s[12:15], s31 offen offset:3072 sc1 lds
  s_add_u32 m0, s24, 4096
  s_nop 0
  buffer_load_dwordx4 v239, s[12:15], s31 offen sc1 lds
  s_add_u32 s31, s31, 5120
  s_add_u32 m0, s24, 5120
  s_nop 0
  buffer_load_dwordx4 v238, s[12:15], s31 offen offset:0 sc1 lds
  buffer_load_dwordx4 v238, s[12:15], s31 offen offset:1024 sc1 lds
  buffer_load_dwordx4 v238, s[12:15], s31 offen offset:2048 sc1 lds
  buffer_load_dwordx4 v238, s[12:15], s31 offen offset:3072 sc1 lds
  s_add_u32 m0, s24, 9216
  s_nop 0
  buffer_load_dwordx4 v239, s[12:15], s31 offen sc1 lds
  s_add_u32 s31, s31, 5120
  s_add_u32 m0, s24, 10240
  s_nop 0
  buffer_load_dwordx4 v238, s[12:15], s31 offen offset:0 sc1 lds
  buffer_load_dwordx4 v238, s[12:15], s31 offen offset:1024 sc1 lds
  buffer_load_dwordx4 v238, s[12:15], s31 offen offset:2048 sc1 lds
  buffer_load_dwordx4 v238, s[12:15], s31 offen offset:3072 sc1 lds
  s_add_u32 m0, s24, 14336
  s_nop 0
  buffer_load_dwordx4 v239, s[12:15], s31 offen sc1 lds
  s_add_u32 s31, s31, 5120
  s_add_u32 m0, s24, 15360
  s_nop 0
  buffer_load_dwordx4 v238, s[12:15], s31 offen offset:0 sc1 lds
  buffer_load_dwordx4 v238, s[12:15], s31 offen offset:1024 sc1 lds
  buffer_load_dwordx4 v238, s[12:15], s31 offen offset:2048 sc1 lds
  buffer_load_dwordx4 v238, s[12:15], s31 offen offset:3072 sc1 lds
  s_add_u32 m0, s24, 19456
  s_nop 0
  buffer_load_dwordx4 v239, s[12:15], s31 offen sc1 lds
  s_add_u32 s31, s31, 5120
  v_lshlrev_b32 v240, 7, v240
  s_mov_b32 s26, 0x100000
  s_mov_b32 s83, 49152
FPH2_loop:
  buffer_load_dword v241, v240, s[64:67], s83 offen sc1
  s_sub_u32 s26, s26, 1
  s_cbranch_scc1 FPH2_done
  s_waitcnt vmcnt(0)
  v_cmp_ne_u32 vcc, s82, v241
  s_cbranch_vccz FPH2_done
  s_sleep 1
  s_branch FPH2_loop
FPH2_done:
  s_mul_i32 s33, s20, 5
  s_add_u32 s33, s33, 54
  s_mul_i32 s35, s33, 5120
  ds_read_b128 v[144:147], v247 offset:0
  ds_read_b128 v[148:151], v247 offset:1024
  ds_read_b128 v[152:155], v247 offset:2048
  ds_read_b128 v[156:159], v247 offset:3072
  ds_read_b128 v[160:163], v247 offset:4096
  buffer_load_dwordx4 v[80:83], v234, s[8:11], s30 offen sc1
  buffer_load_dwordx4 v[84:87], v235, s[8:11], s30 offen sc1
  buffer_load_dwordx4 v[88:91], v236, s[8:11], s30 offen sc1
  buffer_load_dwordx4 v[92:95], v237, s[8:11], s30 offen sc1
  s_add_u32 s30, s30, 1024
  buffer_load_dwordx4 v[96:99], v234, s[8:11], s30 offen sc1
  buffer_load_dwordx4 v[100:103], v235, s[8:11], s30 offen sc1
  buffer_load_dwordx4 v[104:107], v236, s[8:11], s30 offen sc1
  buffer_load_dwordx4 v[108:111], v237, s[8:11], s30 offen sc1
  s_add_u32 s30, s30, 1024
  buffer_load_dwordx4 v[112:115], v234, s[8:11], s30 offen sc1
  buffer_load_dwordx4 v[116:119], v235, s[8:11], s30 offen sc1
  buffer_load_dwordx4 v[120:123], v236, s[8:11], s30 offen sc1
  buffer_load_dwordx4 v[124:127], v237, s[8:11], s30 offen sc1
  s_add_u32 s30, s30, 1024
  s_waitcnt vmcnt(8) lgkmcnt(0)
  v_mfma_f32_16x16x32_bf16 v[0:3], v[144:147], v[80:83], 0
  ds_read_b128 v[164:167], v247 offset:5120
  v_mfma_f32_16x16x32_bf16 v[20:23], v[144:147], v[84:87], 0
  ds_read_b128 v[168:171], v247 offset:6144
  v_mfma_f32_16x16x32_bf16 v[40:43], v[144:147], v[88:91], 0
  ds_read_b128 v[172:175], v247 offset:7168
  v_mfma_f32_16x16x32_bf16 v[60:63], v[144:147], v[92:95], 0
  v_mfma_f32_16x16x32_bf16 v[4:7], v[148:151], v[80:83], 0
  ds_read_b128 v[176:179], v247 offset:8192
  v_mfma_f32_16x16x32_bf16 v[24:27], v[148:151], v[84:87], 0
  ds_read_b128 v[180:183], v247 offset:9216
  v_mfma_f32_16x16x32_bf16 v[44:47], v[148:151], v[88:91], 0
  v_mfma_f32_16x16x32_bf16 v[64:67], v[148:151], v[92:95], 0
  s_add_u32 m0, s24, 0
  s_nop 0
  buffer_load_dwordx4 v238, s[12:15], s31 offen sc1 lds
  v_mfma_f32_16x16x32_bf16 v[8:11], v[152:155], v[80:83], 0
  buffer_load_dwordx4 v238, s[12:15], s31 offen offset:1024 sc1 lds
  v_mfma_f32_16x16x32_bf16 v[28:31], v[152:155], v[84:87], 0
  v_mfma_f32_16x16x32_bf16 v[48:51], v[152:155], v[88:91], 0
  buffer_load_dwordx4 v238, s[12:15], s31 offen offset:2048 sc1 lds
  v_mfma_f32_16x16x32_bf16 v[68:71], v[152:155], v[92:95], 0
  buffer_load_dwordx4 v238, s[12:15], s31 offen offset:3072 sc1 lds
  v_mfma_f32_16x16x32_bf16 v[12:15], v[156:159], v[80:83], 0
  s_add_u32 m0, s24, 4096
  s_nop 0
  buffer_load_dwordx4 v239, s[12:15], s31 offen sc1 lds
  s_add_u32 s31, s31, 5120
  v_mfma_f32_16x16x32_bf16 v[32:35], v[156:159], v[84:87], 0
  v_mfma_f32_16x16x32_bf16 v[52:55], v[156:159], v[88:91], 0
  buffer_load_dwordx4 v[128:131], v234, s[8:11], s30 offen sc1
  v_mfma_f32_16x16x32_bf16 v[72:75], v[156:159], v[92:95], 0
  buffer_load_dwordx4 v[132:135], v235, s[8:11], s30 offen sc1
  v_mfma_f32_16x16x32_bf16 v[16:19], v[160:163], v[80:83], 0
  v_mfma_f32_16x16x32_bf16 v[36:39], v[160:163], v[84:87], 0
  buffer_load_dwordx4 v[136:139], v236, s[8:11], s30 offen sc1
  v_mfma_f32_16x16x32_bf16 v[56:59], v[160:163], v[88:91], 0
  buffer_load_dwordx4 v[140:143], v237, s[8:11], s30 offen sc1
  s_add_u32 s30, s30, 1024
  v_mfma_f32_16x16x32_bf16 v[76:79], v[160:163], v[92:95], 0
  s_waitcnt vmcnt(13) lgkmcnt(0)
  v_mfma_f32_16x16x32_bf16 v[0:3], v[164:167], v[96:99], v[0:3]
  ds_read_b128 v[144:147], v247 offset:10240
  v_mfma_f32_16x16x32_bf16 v[20:23], v[164:167], v[100:103], v[20:23]
  ds_read_b128 v[148:151], v247 offset:11264
  v_mfma_f32_16x16x32_bf16 v[40:43], v[164:167], v[104:107], v[40:43]
  ds_read_b128 v[152:155], v247 offset:12288
  v_mfma_f32_16x16x32_bf16 v[60:63], v[164:167], v[108:111], v[60:63]
  v_mfma_f32_16x16x32_bf16 v[4:7], v[168:171], v[96:99], v[4:7]
  ds_read_b128 v[156:159], v247 offset:13312
  v_mfma_f32_16x16x32_bf16 v[24:27], v[168:171], v[100:103], v[24:27]
  ds_read_b128 v[160:163], v247 offset:14336
  v_mfma_f32_16x16x32_bf16 v[44:47], v[168:171], v[104:107], v[44:47]
  v_mfma_f32_16x16x32_bf16 v[64:67], v[168:171], v[108:111], v[64:67]
  s_add_u32 m0, s24, 5120
  s_nop 0
  buffer_load_dwordx4 v238, s[12:15], s31 offen sc1 lds
  v_mfma_f32_16x16x32_bf16 v[8:11], v[172:175], v[96:99], v[8:11]
  buffer_load_dwordx4 v238, s[12:15], s31 offen offset:1024 sc1 lds
  v_mfma_f32_16x16x32_bf16 v[28:31], v[172:175], v[100:103], v[28:31]
  v_mfma_f32_16x16x32_bf16 v[48:51], v[172:175], v[104:107], v[48:51]
  buffer_load_dwordx4 v238, s[12:15], s31 offen offset:2048 sc1 lds
  v_mfma_f32_16x16x32_bf16 v[68:71], v[172:175], v[108:111], v[68:71]
  buffer_load_dwordx4 v238, s[12:15], s31 offen offset:3072 sc1 lds
  v_mfma_f32_16x16x32_bf16 v[12:15], v[176:179], v[96:99], v[12:15]
  s_add_u32 m0, s24, 9216
  s_nop 0
  buffer_load_dwordx4 v239, s[12:15], s31 offen sc1 lds
  s_add_u32 s31, s31, 5120
  v_mfma_f32_16x16x32_bf16 v[32:35], v[176:179], v[100:103], v[32:35]
  v_mfma_f32_16x16x32_bf16 v[52:55], v[176:179], v[104:107], v[52:55]
  buffer_load_dwordx4 v[80:83], v234, s[8:11], s30 offen sc1
  v_mfma_f32_16x16x32_bf16 v[72:75], v[176:179], v[108:111], v[72:75]
  buffer_load_dwordx4 v[84:87], v235, s[8:11], s30 offen sc1
  v_mfma_f32_16x16x32_bf16 v[16:19], v[180:183], v[96:99], v[16:19]
  v_mfma_f32_16x16x32_bf16 v[36:39], v[180:183], v[100:103], v[36:39]
  buffer_load_dwordx4 v[88:91], v236, s[8:11], s30 offen sc1
  v_mfma_f32_16x16x32_bf16 v[56:59], v[180:183], v[104:107], v[56:59]
  buffer_load_dwordx4 v[92:95], v237, s[8:11], s30 offen sc1
  s_add_u32 s30, s30, 1024
  v_mfma_f32_16x16x32_bf16 v[76:79], v[180:183], v[108:111], v[76:79]
  s_waitcnt vmcnt(18) lgkmcnt(0)
  v_mfma_f32_16x16x32_bf16 v[0:3], v[144:147], v[112:115], v[0:3]
  ds_read_b128 v[164:167], v247 offset:15360
  v_mfma_f32_16x16x32_bf16 v[20:23], v[144:147], v[116:119], v[20:23]
  ds_read_b128 v[168:171], v247 offset:16384
  v_mfma_f32_16x16x32_bf16 v[40:43], v[144:147], v[120:123], v[40:43]
  ds_read_b128 v[172:175], v247 offset:17408
  v_mfma_f32_16x16x32_bf16 v[60:63], v[144:147], v[124:127], v[60:63]
  v_mfma_f32_16x16x32_bf16 v[4:7], v[148:151], v[112:115], v[4:7]
  ds_read_b128 v[176:179], v247 offset:18432
  v_mfma_f32_16x16x32_bf16 v[24:27], v[148:151], v[116:119], v[24:27]
  ds_read_b128 v[180:183], v247 offset:19456
  v_mfma_f32_16x16x32_bf16 v[44:47], v[148:151], v[120:123], v[44:47]
  v_mfma_f32_16x16x32_bf16 v[64:67], v[148:151], v[124:127], v[64:67]
  s_add_u32 m0, s24, 10240
  s_nop 0
  buffer_load_dwordx4 v238, s[12:15], s31 offen sc1 lds
  v_mfma_f32_16x16x32_bf16 v[8:11], v[152:155], v[112:115], v[8:11]
  buffer_load_dwordx4 v238, s[12:15], s31 offen offset:1024 sc1 lds
  v_mfma_f32_16x16x32_bf16 v[28:31], v[152:155], v[116:119], v[28:31]
  v_mfma_f32_16x16x32_bf16 v[48:51], v[152:155], v[120:123], v[48:51]
  buffer_load_dwordx4 v238, s[12:15], s31 offen offset:2048 sc1 lds
  v_mfma_f32_16x16x32_bf16 v[68:71], v[152:155], v[124:127], v[68:71]
  buffer_load_dwordx4 v238, s[12:15], s31 offen offset:3072 sc1 lds
  v_mfma_f32_16x16x32_bf16 v[12:15], v[156:159], v[112:115], v[12:15]
  s_add_u32 m0, s24, 14336
  s_nop 0
  buffer_load_dwordx4 v239, s[12:15], s31 offen sc1 lds
  s_add_u32 s31, s31, 5120
  v_mfma_f32_16x16x32_bf16 v[32:35], v[156:159], v[116:119], v[32:35]
  v_mfma_f32_16x16x32_bf16 v[52:55], v[156:159], v[120:123], v[52:55]
  buffer_load_dwordx4 v[96:99], v234, s[8:11], s30 offen sc1
  v_mfma_f32_16x16x32_bf16 v[72:75], v[156:159], v[124:127], v[72:75]
  buffer_load_dwordx4 v[100:103], v235, s[8:11], s30 offen sc1
  v_mfma_f32_16x16x32_bf16 v[16:19], v[160:163], v[112:115], v[16:19]
  v_mfma_f32_16x16x32_bf16 v[36:39], v[160:163], v[116:119], v[36:39]
  buffer_load_dwordx4 v[104:107], v236, s[8:11], s30 offen sc1
  v_mfma_f32_16x16x32_bf16 v[56:59], v[160:163], v[120:123], v[56:59]
  buffer_load_dwordx4 v[108:111], v237, s[8:11], s30 offen sc1
  s_add_u32 s30, s30, 1024
  v_mfma_f32_16x16x32_bf16 v[76:79], v[160:163], v[124:127], v[76:79]
  s_waitcnt vmcnt(18) lgkmcnt(0)
  v_mfma_f32_16x16x32_bf16 v[0:3], v[164:167], v[128:131], v[0:3]
  ds_read_b128 v[144:147], v247 offset:0
  v_mfma_f32_16x16x32_bf16 v[20:23], v[164:167], v[132:135], v[20:23]
  ds_read_b128 v[148:151], v247 offset:1024
  v_mfma_f32_16x16x32_bf16 v[40:43], v[164:167], v[136:139], v[40:43]
  ds_read_b128 v[152:155], v247 offset:2048
  v_mfma_f32_16x16x32_bf16 v[60:63], v[164:167], v[140:143], v[60:63]
  v_mfma_f32_16x16x32_bf16 v[4:7], v[168:171], v[128:131], v[4:7]
  ds_read_b128 v[156:159], v247 offset:3072
  v_mfma_f32_16x16x32_bf16 v[24:27], v[168:171], v[132:135], v[24:27]
  ds_read_b128 v[160:163], v247 offset:4096
  v_mfma_f32_16x16x32_bf16 v[44:47], v[168:171], v[136:139], v[44:47]
  v_mfma_f32_16x16x32_bf16 v[64:67], v[168:171], v[140:143], v[64:67]
  s_add_u32 m0, s24, 15360
  s_nop 0
  buffer_load_dwordx4 v238, s[12:15], s31 offen sc1 lds
  v_mfma_f32_16x16x32_bf16 v[8:11], v[172:175], v[128:131], v[8:11]
  buffer_load_dwordx4 v238, s[12:15], s31 offen offset:1024 sc1 lds
  v_mfma_f32_16x16x32_bf16 v[28:31], v[172:175], v[132:135], v[28:31]
  v_mfma_f32_16x16x32_bf16 v[48:51], v[172:175], v[136:139], v[48:51]
  buffer_load_dwordx4 v238, s[12:15], s31 offen offset:2048 sc1 lds
  v_mfma_f32_16x16x32_bf16 v[68:71], v[172:175], v[140:143], v[68:71]
  buffer_load_dwordx4 v238, s[12:15], s31 offen offset:3072 sc1 lds
  v_mfma_f32_16x16x32_bf16 v[12:15], v[176:179], v[128:131], v[12:15]
  s_add_u32 m0, s24, 19456
  s_nop 0
  buffer_load_dwordx4 v239, s[12:15], s31 offen sc1 lds
  s_add_u32 s31, s31, 5120
  v_mfma_f32_16x16x32_bf16 v[32:35], v[176:179], v[132:135], v[32:35]
  v_mfma_f32_16x16x32_bf16 v[52:55], v[176:179], v[136:139], v[52:55]
  buffer_load_dwordx4 v[112:115], v234, s[8:11], s30 offen sc1
  v_mfma_f32_16x16x32_bf16 v[72:75], v[176:179], v[140:143], v[72:75]
  buffer_load_dwordx4 v[116:119], v235, s[8:11], s30 offen sc1
  v_mfma_f32_16x16x32_bf16 v[16:19], v[180:183], v[128:131], v[16:19]
  v_mfma_f32_16x16x32_bf16 v[36:39], v[180:183], v[132:135], v[36:39]
  buffer_load_dwordx4 v[120:123], v236, s[8:11], s30 offen sc1
  v_mfma_f32_16x16x32_bf16 v[56:59], v[180:183], v[136:139], v[56:59]
  buffer_load_dwordx4 v[124:127], v237, s[8:11], s30 offen sc1
  s_add_u32 s30, s30, 1024
  v_mfma_f32_16x16x32_bf16 v[76:79], v[180:183], v[140:143], v[76:79]
  s_waitcnt vmcnt(18) lgkmcnt(0)
  v_mfma_f32_16x16x32_bf16 v[0:3], v[144:147], v[80:83], v[0:3]
  ds_read_b128 v[164:167], v247 offset:5120
  v_mfma_f32_16x16x32_bf16 v[20:23], v[144:147], v[84:87], v[20:23]
  ds_read_b128 v[168:171], v247 offset:6144
  v_mfma_f32_16x16x32_bf16 v[40:43], v[144:147], v[88:91], v[40:43]
  ds_read_b128 v[172:175], v247 offset:7168
  v_mfma_f32_16x16x32_bf16 v[60:63], v[144:147], v[92:95], v[60:63]
  v_mfma_f32_16x16x32_bf16 v[4:7], v[148:151], v[80:83], v[4:7]
  ds_read_b128 v[176:179], v247 offset:8192
  v_mfma_f32_16x16x32_bf16 v[24:27], v[148:151], v[84:87], v[24:27]
  ds_read_b128 v[180:183], v247 offset:9216
  v_mfma_f32_16x16x32_bf16 v[44:47], v[148:151], v[88:91], v[44:47]
  v_mfma_f32_16x16x32_bf16 v[64:67], v[148:151], v[92:95], v[64:67]
  s_add_u32 m0, s24, 0
  s_nop 0
  buffer_load_dwordx4 v238, s[12:15], s31 offen sc1 lds
  v_mfma_f32_16x16x32_bf16 v[8:11], v[152:155], v[80:83], v[8:11]
  buffer_load_dwordx4 v238, s[12:15], s31 offen offset:1024 sc1 lds
  v_mfma_f32_16x16x32_bf16 v[28:31], v[152:155], v[84:87], v[28:31]
  v_mfma_f32_16x16x32_bf16 v[48:51], v[152:155], v[88:91], v[48:51]
  buffer_load_dwordx4 v238, s[12:15], s31 offen offset:2048 sc1 lds
  v_mfma_f32_16x16x32_bf16 v[68:71], v[152:155], v[92:95], v[68:71]
  buffer_load_dwordx4 v238, s[12:15], s31 offen offset:3072 sc1 lds
  v_mfma_f32_16x16x32_bf16 v[12:15], v[156:159], v[80:83], v[12:15]
  s_add_u32 m0, s24, 4096
  s_nop 0
  buffer_load_dwordx4 v239, s[12:15], s31 offen sc1 lds
  s_add_u32 s31, s31, 5120
  v_mfma_f32_16x16x32_bf16 v[32:35], v[156:159], v[84:87], v[32:35]
  v_mfma_f32_16x16x32_bf16 v[52:55], v[156:159], v[88:91], v[52:55]
  buffer_load_dwordx4 v[128:131], v234, s[8:11], s30 offen sc1
  v_mfma_f32_16x16x32_bf16 v[72:75], v[156:159], v[92:95], v[72:75]
  buffer_load_dwordx4 v[132:135], v235, s[8:11], s30 offen sc1
  v_mfma_f32_16x16x32_bf16 v[16:19], v[160:163], v[80:83], v[16:19]
  v_mfma_f32_16x16x32_bf16 v[36:39], v[160:163], v[84:87], v[36:39]
  buffer_load_dwordx4 v[136:139], v236, s[8:11], s30 offen sc1
  v_mfma_f32_16x16x32_bf16 v[56:59], v[160:163], v[88:91], v[56:59]
  buffer_load_dwordx4 v[140:143], v237, s[8:11], s30 offen sc1
  s_add_u32 s30, s30, 1024
  v_mfma_f32_16x16x32_bf16 v[76:79], v[160:163], v[92:95], v[76:79]
  s_waitcnt vmcnt(18) lgkmcnt(0)
  v_mfma_f32_16x16x32_bf16 v[0:3], v[164:167], v[96:99], v[0:3]
  ds_read_b128 v[144:147], v247 offset:10240
  v_mfma_f32_16x16x32_bf16 v[20:23], v[164:167], v[100:103], v[20:23]
  ds_read_b128 v[148:151], v247 offset:11264
  v_mfma_f32_16x16x32_bf16 v[40:43], v[164:167], v[104:107], v[40:43]
  ds_read_b128 v[152:155], v247 offset:12288
  v_mfma_f32_16x16x32_bf16 v[60:63], v[164:167], v[108:111], v[60:63]
  v_mfma_f32_16x16x32_bf16 v[4:7], v[168:171], v[96:99], v[4:7]
  ds_read_b128 v[156:159], v247 offset:13312
  v_mfma_f32_16x16x32_bf16 v[24:27], v[168:171], v[100:103], v[24:27]
  ds_read_b128 v[160:163], v247 offset:14336
  v_mfma_f32_16x16x32_bf16 v[44:47], v[168:171], v[104:107], v[44:47]
  v_mfma_f32_16x16x32_bf16 v[64:67], v[168:171], v[108:111], v[64:67]
  s_add_u32 m0, s24, 5120
  s_nop 0
  buffer_load_dwordx4 v238, s[12:15], s31 offen sc1 lds
  v_mfma_f32_16x16x32_bf16 v[8:11], v[172:175], v[96:99], v[8:11]
  buffer_load_dwordx4 v238, s[12:15], s31 offen offset:1024 sc1 lds
  v_mfma_f32_16x16x32_bf16 v[28:31], v[172:175], v[100:103], v[28:31]
  v_mfma_f32_16x16x32_bf16 v[48:51], v[172:175], v[104:107], v[48:51]
  buffer_load_dwordx4 v238, s[12:15], s31 offen offset:2048 sc1 lds
  v_mfma_f32_16x16x32_bf16 v[68:71], v[172:175], v[108:111], v[68:71]
  buffer_load_dwordx4 v238, s[12:15], s31 offen offset:3072 sc1 lds
  v_mfma_f32_16x16x32_bf16 v[12:15], v[176:179], v[96:99], v[12:15]
  s_add_u32 m0, s24, 9216
  s_nop 0
  buffer_load_dwordx4 v239, s[12:15], s31 offen sc1 lds
  s_add_u32 s31, s31, 5120
  v_mfma_f32_16x16x32_bf16 v[32:35], v[176:179], v[100:103], v[32:35]
  v_mfma_f32_16x16x32_bf16 v[52:55], v[176:179], v[104:107], v[52:55]
  buffer_load_dwordx4 v[80:83], v234, s[8:11], s30 offen sc1
  v_mfma_f32_16x16x32_bf16 v[72:75], v[176:179], v[108:111], v[72:75]
  buffer_load_dwordx4 v[84:87], v235, s[8:11], s30 offen sc1
  v_mfma_f32_16x16x32_bf16 v[16:19], v[180:183], v[96:99], v[16:19]
  v_mfma_f32_16x16x32_bf16 v[36:39], v[180:183], v[100:103], v[36:39]
  buffer_load_dwordx4 v[88:91], v236, s[8:11], s30 offen sc1
  v_mfma_f32_16x16x32_bf16 v[56:59], v[180:183], v[104:107], v[56:59]
  buffer_load_dwordx4 v[92:95], v237, s[8:11], s30 offen sc1
  s_add_u32 s30, s30, 1024
  v_mfma_f32_16x16x32_bf16 v[76:79], v[180:183], v[108:111], v[76:79]
  s_waitcnt vmcnt(18) lgkmcnt(0)
  v_mfma_f32_16x16x32_bf16 v[0:3], v[144:147], v[112:115], v[0:3]
  ds_read_b128 v[164:167], v247 offset:15360
  v_mfma_f32_16x16x32_bf16 v[20:23], v[144:147], v[116:119], v[20:23]
  ds_read_b128 v[168:171], v247 offset:16384
  v_mfma_f32_16x16x32_bf16 v[40:43], v[144:147], v[120:123], v[40:43]
  ds_read_b128 v[172:175], v247 offset:17408
  v_mfma_f32_16x16x32_bf16 v[60:63], v[144:147], v[124:127], v[60:63]
  v_mfma_f32_16x16x32_bf16 v[4:7], v[148:151], v[112:115], v[4:7]
  ds_read_b128 v[176:179], v247 offset:18432
  v_mfma_f32_16x16x32_bf16 v[24:27], v[148:151], v[116:119], v[24:27]
  ds_read_b128 v[180:183], v247 offset:19456
  v_mfma_f32_16x16x32_bf16 v[44:47], v[148:151], v[120:123], v[44:47]
  v_mfma_f32_16x16x32_bf16 v[64:67], v[148:151], v[124:127], v[64:67]
  s_add_u32 m0, s24, 10240
  s_nop 0
  buffer_load_dwordx4 v238, s[12:15], s31 offen sc1 lds
  v_mfma_f32_16x16x32_bf16 v[8:11], v[152:155], v[112:115], v[8:11]
  buffer_load_dwordx4 v238, s[12:15], s31 offen offset:1024 sc1 lds
  v_mfma_f32_16x16x32_bf16 v[28:31], v[152:155], v[116:119], v[28:31]
  v_mfma_f32_16x16x32_bf16 v[48:51], v[152:155], v[120:123], v[48:51]
  buffer_load_dwordx4 v238, s[12:15], s31 offen offset:2048 sc1 lds
  v_mfma_f32_16x16x32_bf16 v[68:71], v[152:155], v[124:127], v[68:71]
  buffer_load_dwordx4 v238, s[12:15], s31 offen offset:3072 sc1 lds
  v_mfma_f32_16x16x32_bf16 v[12:15], v[156:159], v[112:115], v[12:15]
  s_add_u32 m0, s24, 14336
  s_nop 0
  buffer_load_dwordx4 v239, s[12:15], s31 offen sc1 lds
  s_add_u32 s31, s31, 5120
  v_mfma_f32_16x16x32_bf16 v[32:35], v[156:159], v[116:119], v[32:35]
  v_mfma_f32_16x16x32_bf16 v[52:55], v[156:159], v[120:123], v[52:55]
  buffer_load_dwordx4 v[96:99], v234, s[8:11], s30 offen sc1
  v_mfma_f32_16x16x32_bf16 v[72:75], v[156:159], v[124:127], v[72:75]
  buffer_load_dwordx4 v[100:103], v235, s[8:11], s30 offen sc1
  v_mfma_f32_16x16x32_bf16 v[16:19], v[160:163], v[112:115], v[16:19]
  v_mfma_f32_16x16x32_bf16 v[36:39], v[160:163], v[116:119], v[36:39]
  buffer_load_dwordx4 v[104:107], v236, s[8:11], s30 offen sc1
  v_mfma_f32_16x16x32_bf16 v[56:59], v[160:163], v[120:123], v[56:59]
  buffer_load_dwordx4 v[108:111], v237, s[8:11], s30 offen sc1
  s_add_u32 s30, s30, 1024
  v_mfma_f32_16x16x32_bf16 v[76:79], v[160:163], v[124:127], v[76:79]
  s_waitcnt vmcnt(18) lgkmcnt(0)
  v_mfma_f32_16x16x32_bf16 v[0:3], v[164:167], v[128:131], v[0:3]
  ds_read_b128 v[144:147], v247 offset:0
  v_mfma_f32_16x16x32_bf16 v[20:23], v[164:167], v[132:135], v[20:23]
  ds_read_b128 v[148:151], v247 offset:1024
  v_mfma_f32_16x16x32_bf16 v[40:43], v[164:167], v[136:139], v[40:43]
  ds_read_b128 v[152:155], v247 offset:2048
  v_mfma_f32_16x16x32_bf16 v[60:63], v[164:167], v[140:143], v[60:63]
  v_mfma_f32_16x16x32_bf16 v[4:7], v[168:171], v[128:131], v[4:7]
  ds_read_b128 v[156:159], v247 offset:3072
  v_mfma_f32_16x16x32_bf16 v[24:27], v[168:171], v[132:135], v[24:27]
  ds_read_b128 v[160:163], v247 offset:4096
  v_mfma_f32_16x16x32_bf16 v[44:47], v[168:171], v[136:139], v[44:47]
  v_mfma_f32_16x16x32_bf16 v[64:67], v[168:171], v[140:143], v[64:67]
  s_add_u32 m0, s24, 15360
  s_nop 0
  buffer_load_dwordx4 v238, s[12:15], s31 offen sc1 lds
  v_mfma_f32_16x16x32_bf16 v[8:11], v[172:175], v[128:131], v[8:11]
  buffer_load_dwordx4 v238, s[12:15], s31 offen offset:1024 sc1 lds
  v_mfma_f32_16x16x32_bf16 v[28:31], v[172:175], v[132:135], v[28:31]
  v_mfma_f32_16x16x32_bf16 v[48:51], v[172:175], v[136:139], v[48:51]
  buffer_load_dwordx4 v238, s[12:15], s31 offen offset:2048 sc1 lds
  v_mfma_f32_16x16x32_bf16 v[68:71], v[172:175], v[140:143], v[68:71]
  buffer_load_dwordx4 v238, s[12:15], s31 offen offset:3072 sc1 lds
  v_mfma_f32_16x16x32_bf16 v[12:15], v[176:179], v[128:131], v[12:15]
  s_add_u32 m0, s24, 19456
  s_nop 0
  buffer_load_dwordx4 v239, s[12:15], s31 offen sc1 lds
  s_add_u32 s31, s31, 5120
  v_mfma_f32_16x16x32_bf16 v[32:35], v[176:179], v[132:135], v[32:35]
  v_mfma_f32_16x16x32_bf16 v[52:55], v[176:179], v[136:139], v[52:55]
  buffer_load_dwordx4 v[112:115], v234, s[8:11], s30 offen sc1
  v_mfma_f32_16x16x32_bf16 v[72:75], v[176:179], v[140:143], v[72:75]
  buffer_load_dwordx4 v[116:119], v235, s[8:11], s30 offen sc1
  v_mfma_f32_16x16x32_bf16 v[16:19], v[180:183], v[128:131], v[16:19]
  v_mfma_f32_16x16x32_bf16 v[36:39], v[180:183], v[132:135], v[36:39]
  buffer_load_dwordx4 v[120:123], v236, s[8:11], s30 offen sc1
  v_mfma_f32_16x16x32_bf16 v[56:59], v[180:183], v[136:139], v[56:59]
  buffer_load_dwordx4 v[124:127], v237, s[8:11], s30 offen sc1
  s_add_u32 s30, s30, 1024
  v_mfma_f32_16x16x32_bf16 v[76:79], v[180:183], v[140:143], v[76:79]
  s_waitcnt vmcnt(18) lgkmcnt(0)
  v_mfma_f32_16x16x32_bf16 v[0:3], v[144:147], v[80:83], v[0:3]
  ds_read_b128 v[164:167], v247 offset:5120
  v_mfma_f32_16x16x32_bf16 v[20:23], v[144:147], v[84:87], v[20:23]
  ds_read_b128 v[168:171], v247 offset:6144
  v_mfma_f32_16x16x32_bf16 v[40:43], v[144:147], v[88:91], v[40:43]
  ds_read_b128 v[172:175], v247 offset:7168
  v_mfma_f32_16x16x32_bf16 v[60:63], v[144:147], v[92:95], v[60:63]
  v_mfma_f32_16x16x32_bf16 v[4:7], v[148:151], v[80:83], v[4:7]
  ds_read_b128 v[176:179], v247 offset:8192
  v_mfma_f32_16x16x32_bf16 v[24:27], v[148:151], v[84:87], v[24:27]
  ds_read_b128 v[180:183], v247 offset:9216
  v_mfma_f32_16x16x32_bf16 v[44:47], v[148:151], v[88:91], v[44:47]
  v_mfma_f32_16x16x32_bf16 v[64:67], v[148:151], v[92:95], v[64:67]
  s_add_u32 m0, s24, 0
  s_nop 0
  buffer_load_dwordx4 v238, s[12:15], s31 offen sc1 lds
  v_mfma_f32_16x16x32_bf16 v[8:11], v[152:155], v[80:83], v[8:11]
  buffer_load_dwordx4 v238, s[12:15], s31 offen offset:1024 sc1 lds
  v_mfma_f32_16x16x32_bf16 v[28:31], v[152:155], v[84:87], v[28:31]
  v_mfma_f32_16x16x32_bf16 v[48:51], v[152:155], v[88:91], v[48:51]
  buffer_load_dwordx4 v238, s[12:15], s31 offen offset:2048 sc1 lds
  v_mfma_f32_16x16x32_bf16 v[68:71], v[152:155], v[92:95], v[68:71]
  buffer_load_dwordx4 v238, s[12:15], s31 offen offset:3072 sc1 lds
  v_mfma_f32_16x16x32_bf16 v[12:15], v[156:159], v[80:83], v[12:15]
  s_add_u32 m0, s24, 4096
  s_nop 0
  buffer_load_dwordx4 v239, s[12:15], s31 offen sc1 lds
  s_add_u32 s31, s31, 5120
  v_mfma_f32_16x16x32_bf16 v[32:35], v[156:159], v[84:87], v[32:35]
  v_mfma_f32_16x16x32_bf16 v[52:55], v[156:159], v[88:91], v[52:55]
  buffer_load_dwordx4 v[128:131], v234, s[8:11], s30 offen sc1
  v_mfma_f32_16x16x32_bf16 v[72:75], v[156:159], v[92:95], v[72:75]
  buffer_load_dwordx4 v[132:135], v235, s[8:11], s30 offen sc1
  v_mfma_f32_16x16x32_bf16 v[16:19], v[160:163], v[80:83], v[16:19]
  v_mfma_f32_16x16x32_bf16 v[36:39], v[160:163], v[84:87], v[36:39]
  buffer_load_dwordx4 v[136:139], v236, s[8:11], s30 offen sc1
  v_mfma_f32_16x16x32_bf16 v[56:59], v[160:163], v[88:91], v[56:59]
  buffer_load_dwordx4 v[140:143], v237, s[8:11], s30 offen sc1
  s_add_u32 s30, s30, 1024
  v_mfma_f32_16x16x32_bf16 v[76:79], v[160:163], v[92:95], v[76:79]
  s_waitcnt vmcnt(18) lgkmcnt(0)
  v_mfma_f32_16x16x32_bf16 v[0:3], v[164:167], v[96:99], v[0:3]
  ds_read_b128 v[144:147], v247 offset:10240
  v_mfma_f32_16x16x32_bf16 v[20:23], v[164:167], v[100:103], v[20:23]
  ds_read_b128 v[148:151], v247 offset:11264
  v_mfma_f32_16x16x32_bf16 v[40:43], v[164:167], v[104:107], v[40:43]
  ds_read_b128 v[152:155], v247 offset:12288
  v_mfma_f32_16x16x32_bf16 v[60:63], v[164:167], v[108:111], v[60:63]
  v_mfma_f32_16x16x32_bf16 v[4:7], v[168:171], v[96:99], v[4:7]
  ds_read_b128 v[156:159], v247 offset:13312
  v_mfma_f32_16x16x32_bf16 v[24:27], v[168:171], v[100:103], v[24:27]
  ds_read_b128 v[160:163], v247 offset:14336
  v_mfma_f32_16x16x32_bf16 v[44:47], v[168:171], v[104:107], v[44:47]
  v_mfma_f32_16x16x32_bf16 v[64:67], v[168:171], v[108:111], v[64:67]
  s_add_u32 m0, s24, 5120
  s_nop 0
  buffer_load_dwordx4 v238, s[12:15], s31 offen sc1 lds
  v_mfma_f32_16x16x32_bf16 v[8:11], v[172:175], v[96:99], v[8:11]
  buffer_load_dwordx4 v238, s[12:15], s31 offen offset:1024 sc1 lds
  v_mfma_f32_16x16x32_bf16 v[28:31], v[172:175], v[100:103], v[28:31]
  v_mfma_f32_16x16x32_bf16 v[48:51], v[172:175], v[104:107], v[48:51]
  buffer_load_dwordx4 v238, s[12:15], s31 offen offset:2048 sc1 lds
  v_mfma_f32_16x16x32_bf16 v[68:71], v[172:175], v[108:111], v[68:71]
  buffer_load_dwordx4 v238, s[12:15], s31 offen offset:3072 sc1 lds
  v_mfma_f32_16x16x32_bf16 v[12:15], v[176:179], v[96:99], v[12:15]
  s_add_u32 m0, s24, 9216
  s_nop 0
  buffer_load_dwordx4 v239, s[12:15], s31 offen sc1 lds
  s_add_u32 s31, s31, 5120
  v_mfma_f32_16x16x32_bf16 v[32:35], v[176:179], v[100:103], v[32:35]
  v_mfma_f32_16x16x32_bf16 v[52:55], v[176:179], v[104:107], v[52:55]
  buffer_load_dwordx4 v[80:83], v234, s[8:11], s30 offen sc1
  v_mfma_f32_16x16x32_bf16 v[72:75], v[176:179], v[108:111], v[72:75]
  buffer_load_dwordx4 v[84:87], v235, s[8:11], s30 offen sc1
  v_mfma_f32_16x16x32_bf16 v[16:19], v[180:183], v[96:99], v[16:19]
  v_mfma_f32_16x16x32_bf16 v[36:39], v[180:183], v[100:103], v[36:39]
  buffer_load_dwordx4 v[88:91], v236, s[8:11], s30 offen sc1
  v_mfma_f32_16x16x32_bf16 v[56:59], v[180:183], v[104:107], v[56:59]
  buffer_load_dwordx4 v[92:95], v237, s[8:11], s30 offen sc1
  s_add_u32 s30, s30, 1024
  v_mfma_f32_16x16x32_bf16 v[76:79], v[180:183], v[108:111], v[76:79]
  s_waitcnt vmcnt(18) lgkmcnt(0)
  v_mfma_f32_16x16x32_bf16 v[0:3], v[144:147], v[112:115], v[0:3]
  ds_read_b128 v[164:167], v247 offset:15360
  v_mfma_f32_16x16x32_bf16 v[20:23], v[144:147], v[116:119], v[20:23]
  ds_read_b128 v[168:171], v247 offset:16384
  v_mfma_f32_16x16x32_bf16 v[40:43], v[144:147], v[120:123], v[40:43]
  ds_read_b128 v[172:175], v247 offset:17408
  v_mfma_f32_16x16x32_bf16 v[60:63], v[144:147], v[124:127], v[60:63]
  v_mfma_f32_16x16x32_bf16 v[4:7], v[148:151], v[112:115], v[4:7]
  ds_read_b128 v[176:179], v247 offset:18432
  v_mfma_f32_16x16x32_bf16 v[24:27], v[148:151], v[116:119], v[24:27]
  ds_read_b128 v[180:183], v247 offset:19456
  v_mfma_f32_16x16x32_bf16 v[44:47], v[148:151], v[120:123], v[44:47]
  v_mfma_f32_16x16x32_bf16 v[64:67], v[148:151], v[124:127], v[64:67]
  s_add_u32 m0, s24, 10240
  s_mov_b32 s31, s35
  buffer_load_dwordx4 v238, s[12:15], s31 offen sc1 lds
  v_mfma_f32_16x16x32_bf16 v[8:11], v[152:155], v[112:115], v[8:11]
  buffer_load_dwordx4 v238, s[12:15], s31 offen offset:1024 sc1 lds
  v_mfma_f32_16x16x32_bf16 v[28:31], v[152:155], v[116:119], v[28:31]
  v_mfma_f32_16x16x32_bf16 v[48:51], v[152:155], v[120:123], v[48:51]
  buffer_load_dwordx4 v238, s[12:15], s31 offen offset:2048 sc1 lds
  v_mfma_f32_16x16x32_bf16 v[68:71], v[152:155], v[124:127], v[68:71]
  buffer_load_dwordx4 v238, s[12:15], s31 offen offset:3072 sc1 lds
  v_mfma_f32_16x16x32_bf16 v[12:15], v[156:159], v[112:115], v[12:15]
  s_add_u32 m0, s24, 14336
  s_nop 0
  buffer_load_dwordx4 v239, s[12:15], s31 offen sc1 lds
  s_add_u32 s31, s31, 5120
  v_mfma_f32_16x16x32_bf16 v[32:35], v[156:159], v[116:119], v[32:35]
  v_mfma_f32_16x16x32_bf16 v[52:55], v[156:159], v[120:123], v[52:55]
  s_cmp_ge_u32 s20, 2
  s_cselect_b32 s30, 0x40000000, s30
  buffer_load_dwordx4 v[96:99], v234, s[8:11], s30 offen sc1
  v_mfma_f32_16x16x32_bf16 v[72:75], v[156:159], v[124:127], v[72:75]
  buffer_load_dwordx4 v[100:103], v235, s[8:11], s30 offen sc1
  v_mfma_f32_16x16x32_bf16 v[16:19], v[160:163], v[112:115], v[16:19]
  v_mfma_f32_16x16x32_bf16 v[36:39], v[160:163], v[116:119], v[36:39]
  buffer_load_dwordx4 v[104:107], v236, s[8:11], s30 offen sc1
  v_mfma_f32_16x16x32_bf16 v[56:59], v[160:163], v[120:123], v[56:59]
  buffer_load_dwordx4 v[108:111], v237, s[8:11], s30 offen sc1
  s_add_u32 s30, s30, 1024
  v_mfma_f32_16x16x32_bf16 v[76:79], v[160:163], v[124:127], v[76:79]
  s_waitcnt vmcnt(18) lgkmcnt(0)
  v_mfma_f32_16x16x32_bf16 v[0:3], v[164:167], v[128:131], v[0:3]
  ds_read_b128 v[144:147], v247 offset:0
  v_mfma_f32_16x16x32_bf16 v[20:23], v[164:167], v[132:135], v[20:23]
  v_mfma_f32_16x16x32_bf16 v[40:43], v[164:167], v[136:139], v[40:43]
  ds_read_b128 v[148:151], v247 offset:1024
  v_mfma_f32_16x16x32_bf16 v[60:63], v[164:167], v[140:143], v[60:63]
  v_mfma_f32_16x16x32_bf16 v[4:7], v[168:171], v[128:131], v[4:7]
  ds_read_b128 v[152:155], v247 offset:2048
  v_mfma_f32_16x16x32_bf16 v[24:27], v[168:171], v[132:135], v[24:27]
  v_mfma_f32_16x16x32_bf16 v[44:47], v[168:171], v[136:139], v[44:47]
  ds_read_b128 v[156:159], v247 offset:3072
  v_mfma_f32_16x16x32_bf16 v[64:67], v[168:171], v[140:143], v[64:67]
  v_mfma_f32_16x16x32_bf16 v[8:11], v[172:175], v[128:131], v[8:11]
  ds_read_b128 v[160:163], v247 offset:4096
  v_mfma_f32_16x16x32_bf16 v[28:31], v[172:175], v[132:135], v[28:31]
  v_mfma_f32_16x16x32_bf16 v[48:51], v[172:175], v[136:139], v[48:51]
  s_add_u32 m0, s24, 15360
  s_nop 0
  buffer_load_dwordx4 v238, s[12:15], s31 offen sc1 lds
  v_mfma_f32_16x16x32_bf16 v[68:71], v[172:175], v[140:143], v[68:71]
  v_mfma_f32_16x16x32_bf16 v[12:15], v[176:179], v[128:131], v[12:15]
  buffer_load_dwordx4 v238, s[12:15], s31 offen offset:1024 sc1 lds
  v_mfma_f32_16x16x32_bf16 v[32:35], v[176:179], v[132:135], v[32:35]
  v_mfma_f32_16x16x32_bf16 v[52:55], v[176:179], v[136:139], v[52:55]
  buffer_load_dwordx4 v238, s[12:15], s31 offen offset:2048 sc1 lds
  v_mfma_f32_16x16x32_bf16 v[72:75], v[176:179], v[140:143], v[72:75]
  v_mfma_f32_16x16x32_bf16 v[16:19], v[180:183], v[128:131], v[16:19]
  buffer_load_dwordx4 v238, s[12:15], s31 offen offset:3072 sc1 lds
  v_mfma_f32_16x16x32_bf16 v[36:39], v[180:183], v[132:135], v[36:39]
  v_mfma_f32_16x16x32_bf16 v[56:59], v[180:183], v[136:139], v[56:59]
  s_add_u32 m0, s24, 19456
  s_nop 0
  buffer_load_dwordx4 v239, s[12:15], s31 offen sc1 lds
  s_add_u32 s31, s31, 5120
  v_mfma_f32_16x16x32_bf16 v[76:79], v[180:183], v[140:143], v[76:79]
  s_waitcnt vmcnt(14) lgkmcnt(0)
  v_mfma_f32_16x16x32_bf16 v[0:3], v[144:147], v[80:83], v[0:3]
  ds_read_b128 v[164:167], v247 offset:5120
  v_mfma_f32_16x16x32_bf16 v[20:23], v[144:147], v[84:87], v[20:23]
  v_mfma_f32_16x16x32_bf16 v[40:43], v[144:147], v[88:91], v[40:43]
  ds_read_b128 v[168:171], v247 offset:6144
  v_mfma_f32_16x16x32_bf16 v[60:63], v[144:147], v[92:95], v[60:63]
  v_mfma_f32_16x16x32_bf16 v[4:7], v[148:151], v[80:83], v[4:7]
  ds_read_b128 v[172:175], v247 offset:7168
  v_mfma_f32_16x16x32_bf16 v[24:27], v[148:151], v[84:87], v[24:27]
  v_mfma_f32_16x16x32_bf16 v[44:47], v[148:151], v[88:91], v[44:47]
  ds_read_b128 v[176:179], v247 offset:8192
  v_mfma_f32_16x16x32_bf16 v[64:67], v[148:151], v[92:95], v[64:67]
  v_mfma_f32_16x16x32_bf16 v[8:11], v[152:155], v[80:83], v[8:11]
  ds_read_b128 v[180:183], v247 offset:9216
  v_mfma_f32_16x16x32_bf16 v[28:31], v[152:155], v[84:87], v[28:31]
  v_mfma_f32_16x16x32_bf16 v[48:51], v[152:155], v[88:91], v[48:51]
  s_add_u32 m0, s24, 0
  s_nop 0
  buffer_load_dwordx4 v238, s[12:15], s31 offen sc1 lds
  v_mfma_f32_16x16x32_bf16 v[68:71], v[152:155], v[92:95], v[68:71]
  v_mfma_f32_16x16x32_bf16 v[12:15], v[156:159], v[80:83], v[12:15]
  buffer_load_dwordx4 v238, s[12:15], s31 offen offset:1024 sc1 lds
  v_mfma_f32_16x16x32_bf16 v[32:35], v[156:159], v[84:87], v[32:35]
  v_mfma_f32_16x16x32_bf16 v[52:55], v[156:159], v[88:91], v[52:55]
  buffer_load_dwordx4 v238, s[12:15], s31 offen offset:2048 sc1 lds
  v_mfma_f32_16x16x32_bf16 v[72:75], v[156:159], v[92:95], v[72:75]
  v_mfma_f32_16x16x32_bf16 v[16:19], v[160:163], v[80:83], v[16:19]
  buffer_load_dwordx4 v238, s[12:15], s31 offen offset:3072 sc1 lds
  v_mfma_f32_16x16x32_bf16 v[36:39], v[160:163], v[84:87], v[36:39]
  v_mfma_f32_16x16x32_bf16 v[56:59], v[160:163], v[88:91], v[56:59]
  s_add_u32 m0, s24, 4096
  s_nop 0
  buffer_load_dwordx4 v239, s[12:15], s31 offen sc1 lds
  s_add_u32 s31, s31, 5120
  v_mfma_f32_16x16x32_bf16 v[76:79], v[160:163], v[92:95], v[76:79]
  s_waitcnt vmcnt(10) lgkmcnt(0)
  v_mfma_f32_16x16x32_bf16 v[0:3], v[164:167], v[96:99], v[0:3]
  ds_read_b128 v[144:147], v247 offset:10240
  v_mfma_f32_16x16x32_bf16 v[20:23], v[164:167], v[100:103], v[20:23]
  v_mfma_f32_16x16x32_bf16 v[40:43], v[164:167], v[104:107], v[40:43]
  ds_read_b128 v[148:151], v247 offset:11264
  v_mfma_f32_16x16x32_bf16 v[60:63], v[164:167], v[108:111], v[60:63]
  v_mfma_f32_16x16x32_bf16 v[4:7], v[168:171], v[96:99], v[4:7]
  ds_read_b128 v[152:155], v247 offset:12288
  v_mfma_f32_16x16x32_bf16 v[24:27], v[168:171], v[100:103], v[24:27]
  v_mfma_f32_16x16x32_bf16 v[44:47], v[168:171], v[104:107], v[44:47]
  ds_read_b128 v[156:159], v247 offset:13312
  v_mfma_f32_16x16x32_bf16 v[64:67], v[168:171], v[108:111], v[64:67]
  v_mfma_f32_16x16x32_bf16 v[8:11], v[172:175], v[96:99], v[8:11]
  ds_read_b128 v[160:163], v247 offset:14336
  v_mfma_f32_16x16x32_bf16 v[28:31], v[172:175], v[100:103], v[28:31]
  v_mfma_f32_16x16x32_bf16 v[48:51], v[172:175], v[104:107], v[48:51]
  s_add_u32 m0, s24, 5120
  s_nop 0
  buffer_load_dwordx4 v238, s[12:15], s31 offen sc1 lds
  v_mfma_f32_16x16x32_bf16 v[68:71], v[172:175], v[108:111], v[68:71]
  v_mfma_f32_16x16x32_bf16 v[12:15], v[176:179], v[96:99], v[12:15]
  buffer_load_dwordx4 v238, s[12:15], s31 offen offset:1024 sc1 lds
  v_mfma_f32_16x16x32_bf16 v[32:35], v[176:179], v[100:103], v[32:35]
  v_mfma_f32_16x16x32_bf16 v[52:55], v[176:179], v[104:107], v[52:55]
  buffer_load_dwordx4 v238, s[12:15], s31 offen offset:2048 sc1 lds
  v_mfma_f32_16x16x32_bf16 v[72:75], v[176:179], v[108:111], v[72:75]
  v_mfma_f32_16x16x32_bf16 v[16:19], v[180:183], v[96:99], v[16:19]
  buffer_load_dwordx4 v238, s[12:15], s31 offen offset:3072 sc1 lds
  v_mfma_f32_16x16x32_bf16 v[36:39], v[180:183], v[100:103], v[36:39]
  v_mfma_f32_16x16x32_bf16 v[56:59], v[180:183], v[104:107], v[56:59]
  s_add_u32 m0, s24, 9216
  s_nop 0
  buffer_load_dwordx4 v239, s[12:15], s31 offen sc1 lds
  s_add_u32 s31, s31, 5120
  v_mfma_f32_16x16x32_bf16 v[76:79], v[180:183], v[108:111], v[76:79]
  v_mov_b32 v240, 73728
  s_mov_b32 s26, 0x1000000
GO_sp:
  ds_read_b32 v241, v240 offset:8
  s_sub_u32 s26, s26, 1
  s_cbranch_scc1 GO_dn
  s_waitcnt lgkmcnt(0)
  v_readfirstlane_b32 s3, v241
  s_cmp_lg_u32 s3, 0
  s_cbranch_scc1 GO_dn
  s_sleep 1
  s_branch GO_sp
GO_dn:
  s_lshl_b32 s30, s33, 10
  buffer_load_dwordx4 v[112:115], v234, s[8:11], s30 offen sc1
  buffer_load_dwordx4 v[116:119], v235, s[8:11], s30 offen sc1
  buffer_load_dwordx4 v[120:123], v236, s[8:11], s30 offen sc1
  buffer_load_dwordx4 v[124:127], v237, s[8:11], s30 offen sc1
  s_add_u32 s30, s30, 1024
  buffer_load_dwordx4 v[128:131], v234, s[8:11], s30 offen sc1
  buffer_load_dwordx4 v[132:135], v235, s[8:11], s30 offen sc1
  buffer_load_dwordx4 v[136:139], v236, s[8:11], s30 offen sc1
  buffer_load_dwordx4 v[140:143], v237, s[8:11], s30 offen sc1
  s_add_u32 s30, s30, 1024
  buffer_load_dwordx4 v[80:83], v234, s[8:11], s30 offen sc1
  buffer_load_dwordx4 v[84:87], v235, s[8:11], s30 offen sc1
  buffer_load_dwordx4 v[88:91], v236, s[8:11], s30 offen sc1
  buffer_load_dwordx4 v[92:95], v237, s[8:11], s30 offen sc1
  s_add_u32 s30, s30, 1024
  s_waitcnt vmcnt(8) lgkmcnt(0)
  v_mfma_f32_16x16x32_bf16 v[0:3], v[144:147], v[112:115], v[0:3]
  ds_read_b128 v[164:167], v247 offset:15360
  v_mfma_f32_16x16x32_bf16 v[20:23], v[144:147], v[116:119], v[20:23]
  ds_read_b128 v[168:171], v247 offset:16384
  v_mfma_f32_16x16x32_bf16 v[40:43], v[144:147], v[120:123], v[40:43]
  ds_read_b128 v[172:175], v247 offset:17408
  v_mfma_f32_16x16x32_bf16 v[60:63], v[144:147], v[124:127], v[60:63]
  v_mfma_f32_16x16x32_bf16 v[4:7], v[148:151], v[112:115], v[4:7]
  ds_read_b128 v[176:179], v247 offset:18432
  v_mfma_f32_16x16x32_bf16 v[24:27], v[148:151], v[116:119], v[24:27]
  ds_read_b128 v[180:183], v247 offset:19456
  v_mfma_f32_16x16x32_bf16 v[44:47], v[148:151], v[120:123], v[44:47]
  v_mfma_f32_16x16x32_bf16 v[64:67], v[148:151], v[124:127], v[64:67]
  s_add_u32 m0, s24, 10240
  s_nop 0
  buffer_load_dwordx4 v238, s[12:15], s31 offen sc1 lds
  v_mfma_f32_16x16x32_bf16 v[8:11], v[152:155], v[112:115], v[8:11]
  buffer_load_dwordx4 v238, s[12:15], s31 offen offset:1024 sc1 lds
  v_mfma_f32_16x16x32_bf16 v[28:31], v[152:155], v[116:119], v[28:31]
  v_mfma_f32_16x16x32_bf16 v[48:51], v[152:155], v[120:123], v[48:51]
  buffer_load_dwordx4 v238, s[12:15], s31 offen offset:2048 sc1 lds
  v_mfma_f32_16x16x32_bf16 v[68:71], v[152:155], v[124:127], v[68:71]
  buffer_load_dwordx4 v238, s[12:15], s31 offen offset:3072 sc1 lds
  v_mfma_f32_16x16x32_bf16 v[12:15], v[156:159], v[112:115], v[12:15]
  s_add_u32 m0, s24, 14336
  s_nop 0
  buffer_load_dwordx4 v239, s[12:15], s31 offen sc1 lds
  s_add_u32 s31, s31, 5120
  v_mfma_f32_16x16x32_bf16 v[32:35], v[156:159], v[116:119], v[32:35]
  v_mfma_f32_16x16x32_bf16 v[52:55], v[156:159], v[120:123], v[52:55]
  buffer_load_dwordx4 v[96:99], v234, s[8:11], s30 offen sc1
  v_mfma_f32_16x16x32_bf16 v[72:75], v[156:159], v[124:127], v[72:75]
  buffer_load_dwordx4 v[100:103], v235, s[8:11], s30 offen sc1
  v_mfma_f32_16x16x32_bf16 v[16:19], v[160:163], v[112:115], v[16:19]
  v_mfma_f32_16x16x32_bf16 v[36:39], v[160:163], v[116:119], v[36:39]
  buffer_load_dwordx4 v[104:107], v236, s[8:11], s30 offen sc1
  v_mfma_f32_16x16x32_bf16 v[56:59], v[160:163], v[120:123], v[56:59]
  buffer_load_dwordx4 v[108:111], v237, s[8:11], s30 offen sc1
  s_add_u32 s30, s30, 1024
  v_mfma_f32_16x16x32_bf16 v[76:79], v[160:163], v[124:127], v[76:79]
  s_waitcnt vmcnt(13) lgkmcnt(0)
  v_mfma_f32_16x16x32_bf16 v[0:3], v[164:167], v[128:131], v[0:3]
  ds_read_b128 v[144:147], v247 offset:0
  v_mfma_f32_16x16x32_bf16 v[20:23], v[164:167], v[132:135], v[20:23]
  v_mfma_f32_16x16x32_bf16 v[40:43], v[164:167], v[136:139], v[40:43]
  ds_read_b128 v[148:151], v247 offset:1024
  v_mfma_f32_16x16x32_bf16 v[60:63], v[164:167], v[140:143], v[60:63]
  v_mfma_f32_16x16x32_bf16 v[4:7], v[168:171], v[128:131], v[4:7]
  ds_read_b128 v[152:155], v247 offset:2048
  v_mfma_f32_16x16x32_bf16 v[24:27], v[168:171], v[132:135], v[24:27]
  v_mfma_f32_16x16x32_bf16 v[44:47], v[168:171], v[136:139], v[44:47]
  ds_read_b128 v[156:159], v247 offset:3072
  v_mfma_f32_16x16x32_bf16 v[64:67], v[168:171], v[140:143], v[64:67]
  v_mfma_f32_16x16x32_bf16 v[8:11], v[172:175], v[128:131], v[8:11]
  ds_read_b128 v[160:163], v247 offset:4096
  v_mfma_f32_16x16x32_bf16 v[28:31], v[172:175], v[132:135], v[28:31]
  v_mfma_f32_16x16x32_bf16 v[48:51], v[172:175], v[136:139], v[48:51]
  v_mfma_f32_16x16x32_bf16 v[68:71], v[172:175], v[140:143], v[68:71]
  buffer_load_dwordx4 v[112:115], v234, s[8:11], s30 offen sc1
  v_mfma_f32_16x16x32_bf16 v[12:15], v[176:179], v[128:131], v[12:15]
  v_mfma_f32_16x16x32_bf16 v[32:35], v[176:179], v[132:135], v[32:35]
  buffer_load_dwordx4 v[116:119], v235, s[8:11], s30 offen sc1
  v_mfma_f32_16x16x32_bf16 v[52:55], v[176:179], v[136:139], v[52:55]
  v_mfma_f32_16x16x32_bf16 v[72:75], v[176:179], v[140:143], v[72:75]
  buffer_load_dwordx4 v[120:123], v236, s[8:11], s30 offen sc1
  v_mfma_f32_16x16x32_bf16 v[16:19], v[180:183], v[128:131], v[16:19]
  v_mfma_f32_16x16x32_bf16 v[36:39], v[180:183], v[132:135], v[36:39]
  buffer_load_dwordx4 v[124:127], v237, s[8:11], s30 offen sc1
  s_add_u32 s30, s30, 1024
  v_mfma_f32_16x16x32_bf16 v[56:59], v[180:183], v[136:139], v[56:59]
  v_mfma_f32_16x16x32_bf16 v[76:79], v[180:183], v[140:143], v[76:79]
  s_waitcnt vmcnt(13) lgkmcnt(0)
  v_mfma_f32_16x16x32_bf16 v[0:3], v[144:147], v[80:83], v[0:3]
  ds_read_b128 v[164:167], v247 offset:5120
  v_mfma_f32_16x16x32_bf16 v[20:23], v[144:147], v[84:87], v[20:23]
  v_mfma_f32_16x16x32_bf16 v[40:43], v[144:147], v[88:91], v[40:43]
  v_mfma_f32_16x16x32_bf16 v[60:63], v[144:147], v[92:95], v[60:63]
  v_mfma_f32_16x16x32_bf16 v[4:7], v[148:151], v[80:83], v[4:7]
  ds_read_b128 v[168:171], v247 offset:6144
  v_mfma_f32_16x16x32_bf16 v[24:27], v[148:151], v[84:87], v[24:27]
  v_mfma_f32_16x16x32_bf16 v[44:47], v[148:151], v[88:91], v[44:47]
  v_mfma_f32_16x16x32_bf16 v[64:67], v[148:151], v[92:95], v[64:67]
  v_mfma_f32_16x16x32_bf16 v[8:11], v[152:155], v[80:83], v[8:11]
  ds_read_b128 v[172:175], v247 offset:7168
  v_mfma_f32_16x16x32_bf16 v[28:31], v[152:155], v[84:87], v[28:31]
  v_mfma_f32_16x16x32_bf16 v[48:51], v[152:155], v[88:91], v[48:51]
  v_mfma_f32_16x16x32_bf16 v[68:71], v[152:155], v[92:95], v[68:71]
  v_mfma_f32_16x16x32_bf16 v[12:15], v[156:159], v[80:83], v[12:15]
  ds_read_b128 v[176:179], v247 offset:8192
  v_mfma_f32_16x16x32_bf16 v[32:35], v[156:159], v[84:87], v[32:35]
  v_mfma_f32_16x16x32_bf16 v[52:55], v[156:159], v[88:91], v[52:55]
  v_mfma_f32_16x16x32_bf16 v[72:75], v[156:159], v[92:95], v[72:75]
  v_mfma_f32_16x16x32_bf16 v[16:19], v[160:163], v[80:83], v[16:19]
  ds_read_b128 v[180:183], v247 offset:9216
  v_mfma_f32_16x16x32_bf16 v[36:39], v[160:163], v[84:87], v[36:39]
  v_mfma_f32_16x16x32_bf16 v[56:59], v[160:163], v[88:91], v[56:59]
  v_mfma_f32_16x16x32_bf16 v[76:79], v[160:163], v[92:95], v[76:79]
  s_waitcnt vmcnt(4) lgkmcnt(0)
  v_mfma_f32_16x16x32_bf16 v[0:3], v[164:167], v[96:99], v[0:3]
  ds_read_b128 v[144:147], v247 offset:10240
  v_mfma_f32_16x16x32_bf16 v[20:23], v[164:167], v[100:103], v[20:23]
  v_mfma_f32_16x16x32_bf16 v[40:43], v[164:167], v[104:107], v[40:43]
  v_mfma_f32_16x16x32_bf16 v[60:63], v[164:167], v[108:111], v[60:63]
  v_mfma_f32_16x16x32_bf16 v[4:7], v[168:171], v[96:99], v[4:7]
  ds_read_b128 v[148:151], v247 offset:11264
  v_mfma_f32_16x16x32_bf16 v[24:27], v[168:171], v[100:103], v[24:27]
  v_mfma_f32_16x16x32_bf16 v[44:47], v[168:171], v[104:107], v[44:47]
  v_mfma_f32_16x16x32_bf16 v[64:67], v[168:171], v[108:111], v[64:67]
  v_mfma_f32_16x16x32_bf16 v[8:11], v[172:175], v[96:99], v[8:11]
  ds_read_b128 v[152:155], v247 offset:12288
  v_mfma_f32_16x16x32_bf16 v[28:31], v[172:175], v[100:103], v[28:31]
  v_mfma_f32_16x16x32_bf16 v[48:51], v[172:175], v[104:107], v[48:51]
  v_mfma_f32_16x16x32_bf16 v[68:71], v[172:175], v[108:111], v[68:71]
  v_mfma_f32_16x16x32_bf16 v[12:15], v[176:179], v[96:99], v[12:15]
  ds_read_b128 v[156:159], v247 offset:13312
  v_mfma_f32_16x16x32_bf16 v[32:35], v[176:179], v[100:103], v[32:35]
  v_mfma_f32_16x16x32_bf16 v[52:55], v[176:179], v[104:107], v[52:55]
  v_mfma_f32_16x16x32_bf16 v[72:75], v[176:179], v[108:111], v[72:75]
  v_mfma_f32_16x16x32_bf16 v[16:19], v[180:183], v[96:99], v[16:19]
  ds_read_b128 v[160:163], v247 offset:14336
  v_mfma_f32_16x16x32_bf16 v[36:39], v[180:183], v[100:103], v[36:39]
  v_mfma_f32_16x16x32_bf16 v[56:59], v[180:183], v[104:107], v[56:59]
  v_mfma_f32_16x16x32_bf16 v[76:79], v[180:183], v[108:111], v[76:79]
  s_waitcnt vmcnt(0) lgkmcnt(0)
  v_mfma_f32_16x16x32_bf16 v[0:3], v[144:147], v[112:115], v[0:3]
  v_mfma_f32_16x16x32_bf16 v[20:23], v[144:147], v[116:119], v[20:23]
  v_mfma_f32_16x16x32_bf16 v[40:43], v[144:147], v[120:123], v[40:43]
  v_mfma_f32_16x16x32_bf16 v[60:63], v[144:147], v[124:127], v[60:63]
  v_mfma_f32_16x16x32_bf16 v[4:7], v[148:151], v[112:115], v[4:7]
  v_mfma_f32_16x16x32_bf16 v[24:27], v[148:151], v[116:119], v[24:27]
  v_mfma_f32_16x16x32_bf16 v[44:47], v[148:151], v[120:123], v[44:47]
  v_mfma_f32_16x16x32_bf16 v[64:67], v[148:151], v[124:127], v[64:67]
  v_mfma_f32_16x16x32_bf16 v[8:11], v[152:155], v[112:115], v[8:11]
  v_mfma_f32_16x16x32_bf16 v[28:31], v[152:155], v[116:119], v[28:31]
  v_mfma_f32_16x16x32_bf16 v[48:51], v[152:155], v[120:123], v[48:51]
  v_mfma_f32_16x16x32_bf16 v[68:71], v[152:155], v[124:127], v[68:71]
  v_mfma_f32_16x16x32_bf16 v[12:15], v[156:159], v[112:115], v[12:15]
  v_mfma_f32_16x16x32_bf16 v[32:35], v[156:159], v[116:119], v[32:35]
  v_mfma_f32_16x16x32_bf16 v[52:55], v[156:159], v[120:123], v[52:55]
  v_mfma_f32_16x16x32_bf16 v[72:75], v[156:159], v[124:127], v[72:75]
  v_mfma_f32_16x16x32_bf16 v[16:19], v[160:163], v[112:115], v[16:19]
  v_mfma_f32_16x16x32_bf16 v[36:39], v[160:163], v[116:119], v[36:39]
  v_mfma_f32_16x16x32_bf16 v[56:59], v[160:163], v[120:123], v[56:59]
  v_mfma_f32_16x16x32_bf16 v[76:79], v[160:163], v[124:127], v[76:79]
  s_mul_i32 s3, s20, 20480
  s_add_u32 s3, s3, 81920
  v_lshl_add_u32 v240, v251, 4, s3
  s_mul_i32 s3, s20, 5120
  s_add_u32 s3, s3, 81920
  v_lshl_add_u32 v241, v251, 4, s3
  v_add_u32 v242, 40960, v241
  s_nop 4
  ds_write_b128 v240, v[0:3] offset:0
  ds_write_b128 v240, v[4:7] offset:1024
  ds_write_b128 v240, v[8:11] offset:2048
  ds_write_b128 v240, v[12:15] offset:3072
  ds_write_b128 v240, v[16:19] offset:4096
  ds_write_b128 v240, v[20:23] offset:5120
  ds_write_b128 v240, v[24:27] offset:6144
  ds_write_b128 v240, v[28:31] offset:7168
  ds_write_b128 v240, v[32:35] offset:8192
  ds_write_b128 v240, v[36:39] offset:9216
  ds_write_b128 v240, v[40:43] offset:10240
  ds_write_b128 v240, v[44:47] offset:11264
  ds_write_b128 v240, v[48:51] offset:12288
  ds_write_b128 v240, v[52:55] offset:13312
  ds_write_b128 v240, v[56:59] offset:14336
  ds_write_b128 v240, v[60:63] offset:15360
  ds_write_b128 v240, v[64:67] offset:16384
  ds_write_b128 v240, v[68:71] offset:17408
  ds_write_b128 v240, v[72:75] offset:18432
  ds_write_b128 v240, v[76:79] offset:19456
  s_waitcnt lgkmcnt(0)
  s_barrier
  ds_read_b128 v[0:3], v241 offset:0
  ds_read_b128 v[4:7], v241 offset:20480
  ds_read_b128 v[8:11], v242 offset:0
  ds_read_b128 v[12:15], v242 offset:20480
  ds_read_b128 v[16:19], v241 offset:1024
  ds_read_b128 v[20:23], v241 offset:21504
  ds_read_b128 v[24:27], v242 offset:1024
  ds_read_b128 v[28:31], v242 offset:21504
  ds_read_b128 v[32:35], v241 offset:2048
  ds_read_b128 v[36:39], v241 offset:22528
  ds_read_b128 v[40:43], v242 offset:2048
  ds_read_b128 v[44:47], v242 offset:22528
  s_waitcnt lgkmcnt(8)
  ds_read_b128 v[48:51], v241 offset:3072
  ds_read_b128 v[52:55], v241 offset:23552
  ds_read_b128 v[56:59], v242 offset:3072
  ds_read_b128 v[60:63], v242 offset:23552
  v_lshlrev_b32 v80, 16, v224
  v_and_b32 v81, 0xffff0000, v224
  v_lshlrev_b32 v82, 16, v225
  v_and_b32 v83, 0xffff0000, v225
  v_pk_add_f32 v[0:1], v[0:1], v[4:5]
  v_pk_add_f32 v[8:9], v[8:9], v[12:13]
  v_pk_add_f32 v[0:1], v[0:1], v[80:81]
  v_pk_add_f32 v[0:1], v[0:1], v[8:9]
  v_pk_add_f32 v[2:3], v[2:3], v[6:7]
  v_pk_add_f32 v[10:11], v[10:11], v[14:15]
  v_pk_add_f32 v[2:3], v[2:3], v[82:83]
  v_pk_add_f32 v[2:3], v[2:3], v[10:11]
  v_cvt_pk_bf16_f32 v4, v0, v1
  v_cvt_pk_bf16_f32 v5, v2, v3
  buffer_store_dwordx2 v[4:5], v248, s[16:19], 0 offen offset:0
  s_waitcnt lgkmcnt(8)
  ds_read_b128 v[64:67], v241 offset:4096
  ds_read_b128 v[68:71], v241 offset:24576
  ds_read_b128 v[72:75], v242 offset:4096
  ds_read_b128 v[76:79], v242 offset:24576
  v_lshlrev_b32 v80, 16, v226
  v_and_b32 v81, 0xffff0000, v226
  v_lshlrev_b32 v82, 16, v227
  v_and_b32 v83, 0xffff0000, v227
  v_pk_add_f32 v[16:17], v[16:17], v[20:21]
  v_pk_add_f32 v[24:25], v[24:25], v[28:29]
  v_pk_add_f32 v[16:17], v[16:17], v[80:81]
  v_pk_add_f32 v[16:17], v[16:17], v[24:25]
  v_pk_add_f32 v[18:19], v[18:19], v[22:23]
  v_pk_add_f32 v[26:27], v[26:27], v[30:31]
  v_pk_add_f32 v[18:19], v[18:19], v[82:83]
  v_pk_add_f32 v[18:19], v[18:19], v[26:27]
  v_cvt_pk_bf16_f32 v20, v16, v17
  v_cvt_pk_bf16_f32 v21, v18, v19
  buffer_store_dwordx2 v[20:21], v248, s[16:19], 0 offen offset:32
  s_waitcnt lgkmcnt(8)
  v_lshlrev_b32 v80, 16, v228
  v_and_b32 v81, 0xffff0000, v228
  v_lshlrev_b32 v82, 16, v229
  v_and_b32 v83, 0xffff0000, v229
  v_pk_add_f32 v[32:33], v[32:33], v[36:37]
  v_pk_add_f32 v[40:41], v[40:41], v[44:45]
  v_pk_add_f32 v[32:33], v[32:33], v[80:81]
  v_pk_add_f32 v[32:33], v[32:33], v[40:41]
  v_pk_add_f32 v[34:35], v[34:35], v[38:39]
  v_pk_add_f32 v[42:43], v[42:43], v[46:47]
  v_pk_add_f32 v[34:35], v[34:35], v[82:83]
  v_pk_add_f32 v[34:35], v[34:35], v[42:43]
  v_cvt_pk_bf16_f32 v36, v32, v33
  v_cvt_pk_bf16_f32 v37, v34, v35
  buffer_store_dwordx2 v[36:37], v248, s[16:19], 0 offen offset:64
  s_waitcnt lgkmcnt(4)
  v_lshlrev_b32 v80, 16, v230
  v_and_b32 v81, 0xffff0000, v230
  v_lshlrev_b32 v82, 16, v231
  v_and_b32 v83, 0xffff0000, v231
  v_pk_add_f32 v[48:49], v[48:49], v[52:53]
  v_pk_add_f32 v[56:57], v[56:57], v[60:61]
  v_pk_add_f32 v[48:49], v[48:49], v[80:81]
  v_pk_add_f32 v[48:49], v[48:49], v[56:57]
  v_pk_add_f32 v[50:51], v[50:51], v[54:55]
  v_pk_add_f32 v[58:59], v[58:59], v[62:63]
  v_pk_add_f32 v[50:51], v[50:51], v[82:83]
  v_pk_add_f32 v[50:51], v[50:51], v[58:59]
  v_cvt_pk_bf16_f32 v52, v48, v49
  v_cvt_pk_bf16_f32 v53, v50, v51
  buffer_store_dwordx2 v[52:53], v248, s[16:19], 0 offen offset:96
  s_waitcnt lgkmcnt(0)
  v_lshlrev_b32 v80, 16, v232
  v_and_b32 v81, 0xffff0000, v232
  v_lshlrev_b32 v82, 16, v233
  v_and_b32 v83, 0xffff0000, v233
  v_pk_add_f32 v[64:65], v[64:65], v[68:69]
  v_pk_add_f32 v[72:73], v[72:73], v[76:77]
  v_pk_add_f32 v[64:65], v[64:65], v[80:81]
  v_pk_add_f32 v[64:65], v[64:65], v[72:73]
  v_pk_add_f32 v[66:67], v[66:67], v[70:71]
  v_pk_add_f32 v[74:75], v[74:75], v[78:79]
  v_pk_add_f32 v[66:67], v[66:67], v[82:83]
  v_pk_add_f32 v[66:67], v[66:67], v[74:75]
  v_cvt_pk_bf16_f32 v68, v64, v65
  v_cvt_pk_bf16_f32 v69, v66, v67
  buffer_store_dwordx2 v[68:69], v248, s[16:19], 0 offen offset:128
  s_endpgm
ATT:
  s_setprio 3
  s_cmp_eq_u32 s44, 1
  s_cbranch_scc1 ATT_kvdone
  s_sub_u32 s23, s20, 4
  s_and_b32 s38, s2, 7
  s_lshr_b32 s39, s2, 3
  s_and_b32 s42, s39, 1
  s_lshl_b32 s21, s38, 1
  s_add_u32 s21, s21, s42
  s_lshr_b32 s22, s39, 1
  s_lshr_b32 s38, s21, 2
  v_and_b32 v230, 3, v251
  v_min_u32 v230, 2, v230
  v_lshl_add_u32 v230, v230, 2, s38
  s_mov_b32 s39, 1431655766
  v_mul_hi_u32 v231, v230, s39
  v_mul_u32_u24 v232, 5, v231
  v_add_u32 v230, v230, v232
  s_lshr_b32 s39, s22, 1
  s_sub_u32 s42, s39, 1
  s_max_i32 s42, s42, 0
  s_lshl_b32 s39, s39, 5
  s_lshl_b32 s42, s42, 5
  v_add_u32 v231, s42, v230
  v_add_u32 v230, s39, v230
  v_cmp_gt_u32 vcc, 32, v251
  s_nop 1
  v_cndmask_b32 v230, v231, v230, vcc
  v_lshlrev_b32 v230, 7, v230
  s_mov_b32 s26, 0x100000
  s_mov_b32 s83, 49152
FPQ2_loop:
  buffer_load_dword v231, v230, s[64:67], s83 offen sc1
  s_sub_u32 s26, s26, 1
  s_cbranch_scc1 FPQ2_done
  s_waitcnt vmcnt(0)
  v_cmp_ne_u32 vcc, s82, v231
  s_cbranch_vccz FPQ2_done
  s_sleep 1
  s_branch FPQ2_loop
FPQ2_done:
  s_lshr_b32 s38, s23, 1
  s_and_b32 s39, s23, 1
  s_lshl_b32 s39, s39, 5
  s_lshl_b32 s42, s21, 1
  s_add_u32 s38, s38, s42
  s_add_u32 s38, s38, s39
  s_add_u32 s38, s38, 32
  s_mul_i32 s38, s38, 98304
  s_add_u32 s8, s48, s38
  s_addc_u32 s9, s49, 0
  s_mov_b32 s10, 98304
  s_mov_b32 s11, 0x20000
  s_mul_i32 s38, s42, 98304
  s_add_u32 s12, s48, s38
  s_addc_u32 s13, s49, 0
  s_mov_b32 s14, 196608
  s_mov_b32 s15, 0x20000
  s_mul_i32 s27, s22, 6144
  s_sub_u32 s27, s27, 12288
  s_mul_i32 s28, s23, 18432
  v_lshlrev_b32 v230, 4, v251
  s_mov_b32 s29, 0
ATT_dmaa:
  s_cmp_lt_i32 s27, 0
  s_cselect_b32 s30, 0x40000000, s27
  s_mov_b32 m0, s28
  s_add_u32 s27, s27, 3072
  s_add_u32 s28, s28, 3072
  buffer_load_dwordx4 v230, s[8:11], s30 offen sc1 lds
  buffer_load_dwordx4 v230, s[8:11], s30 offen offset:1024 sc1 lds
  buffer_load_dwordx4 v230, s[8:11], s30 offen offset:2048 sc1 lds
  s_add_u32 s29, s29, 1
  s_cmp_lt_u32 s29, 6
  s_cbranch_scc1 ATT_dmaa
  s_lshl_b32 s25, s23, 5
  s_lshl_b32 s26, s22, 7
  s_add_u32 s26, s26, s25
  v_and_b32 v231, 31, v251
  v_lshrrev_b32 v232, 5, v251
  v_add_u32 v233, s26, v231
  v_mul_u32_u24 v234, 48, v233
  v_lshlrev_b32 v235, 30, v232
  v_add3_u32 v235, v235, v234, 32
  v_lshl_add_u32 v234, v232, 4, v234
  s_mov_b32 s30, 98304
  buffer_load_dwordx4 v[214:217], v234, s[12:15], 0 offen sc1
  buffer_load_dwordx2 v[218:219], v235, s[12:15], 0 offen sc1
  buffer_load_dwordx4 v[220:223], v234, s[12:15], s30 offen sc1
  buffer_load_dwordx2 v[224:225], v235, s[12:15], s30 offen sc1
ATT_kvdone:
  s_add_u32 s4, s48, 9437184
  s_addc_u32 s5, s49, 0
  s_mov_b32 s6, 9699328
  s_mov_b32 s7, 0x20000
  v_lshlrev_b32 v236, 2, v232
  v_sub_u32 v236, v236, v231
  v_add_u32 v246, 16, v236
  v_mov_b32 v237, 0xf149f2ca
  v_mov_b32 v248, 0x3f803f80
  v_mov_b32 v249, 0x3f803f80
  v_cmp_gt_u32 vcc, 32, v251
  v_add_u32 v238, s25, v231
  v_mul_u32_u24 v238, 48, v238
  v_add_u32 v239, 32, v238
  v_lshl_add_u32 v238, v232, 4, v238
  v_bfe_u32 v240, v251, 2, 2
  v_lshl_add_u32 v240, v232, 2, v240
  v_add_u32 v240, s25, v240
  v_mul_u32_u24 v240, 48, v240
  v_bfe_u32 v241, v251, 4, 1
  v_and_b32 v242, 3, v251
  v_lshl_add_u32 v241, v241, 2, v242
  v_lshlrev_b32 v241, 2, v241
  s_mov_b32 s30, 0x55543120
  s_mov_b32 s31, 0x55504231
  v_lshrrev_b32 v242, v241, s30
  v_lshrrev_b32 v241, v241, s31
  v_and_b32 v242, 15, v242
  v_and_b32 v241, 15, v241
  v_add_u32 v240, 18432, v240
  v_lshl_add_u32 v247, v241, 3, v240
  v_add_u32 v247, 36864, v247
  v_lshl_add_u32 v240, v242, 3, v240
  v_lshrrev_b32 v234, 4, v233
  v_mul_u32_u24 v234, 75776, v234
  v_and_b32 v233, 15, v233
  v_lshl_add_u32 v234, v233, 4, v234
  s_mul_i32 s34, s21, 1280
  s_add_u32 s34, s34, 55296
  v_add_u32 v234, s34, v234
  v_lshl_add_u32 v233, v232, 8, v234
  v_lshlrev_b32 v235, 30, v232
  v_add_u32 v235, v235, v234
  s_lshl_b32 s31, s22, 2
  s_add_u32 s31, s31, s23
  s_sub_i32 s31, 8, s31
  v_mov_b32 v242, 73728
  v_mov_b32 v243, 1
  v_cmp_lt_i32 s[52:53], 0, v236
  v_cmp_lt_i32 s[54:55], -1, v236
  v_cmp_lt_i32 s[56:57], -2, v236
  v_cmp_lt_i32 s[58:59], -3, v236
  v_cmp_lt_i32 s[60:61], -8, v236
  v_cmp_lt_i32 s[62:63], -9, v236
  v_cmp_lt_i32 s[8:9], -10, v236
  v_cmp_lt_i32 s[10:11], -11, v236
  v_cmp_lt_i32 s[12:13], 0, v246
  v_cmp_lt_i32 s[14:15], -1, v246
  v_cmp_lt_i32 s[16:17], -2, v246
  v_cmp_lt_i32 s[18:19], -3, v246
  v_cmp_lt_i32 s[36:37], -8, v246
  v_cmp_lt_i32 s[38:39], -9, v246
  v_cmp_lt_i32 s[40:41], -10, v246
  v_cmp_lt_i32 s[42:43], -11, v246
  s_waitcnt vmcnt(0)
  s_mov_b64 exec, 1
  ds_add_u32 v242, v243
  s_mov_b64 exec, -1
ATT_sp:
  ds_read_b32 v243, v242
  s_waitcnt lgkmcnt(0)
  v_readfirstlane_b32 s3, v243
  s_cmp_lt_u32 s3, 4
  s_cbranch_scc1 ATT_sp
  s_mov_b32 s35, 0
  s_waitcnt lgkmcnt(0)
ATT_u:
  ds_read_b128 v[144:147], v238 offset:0
  ds_read_b64 v[148:149], v239 offset:0
  ds_read_b128 v[150:153], v238 offset:1536
  ds_read_b64 v[154:155], v239 offset:1536
  ds_read_b128 v[156:159], v238 offset:3072
  ds_read_b64 v[160:161], v239 offset:3072
  ds_read_b128 v[162:165], v238 offset:4608
  ds_read_b64 v[166:167], v239 offset:4608
  ds_read_b128 v[168:171], v238 offset:6144
  ds_read_b64 v[172:173], v239 offset:6144
  ds_read_b128 v[174:177], v238 offset:7680
  ds_read_b64 v[178:179], v239 offset:7680
  ds_read_b128 v[180:183], v238 offset:9216
  ds_read_b64 v[184:185], v239 offset:9216
  v_cndmask_b32 v0, v237, 0, s[52:53]
  v_cndmask_b32 v128, 0, v237, s[52:53]
  v_cndmask_b32 v1, v237, 0, s[54:55]
  v_cndmask_b32 v129, 0, v237, s[54:55]
  v_cndmask_b32 v2, v237, 0, s[56:57]
  v_cndmask_b32 v130, 0, v237, s[56:57]
  v_cndmask_b32 v3, v237, 0, s[58:59]
  v_cndmask_b32 v131, 0, v237, s[58:59]
  v_cndmask_b32 v4, v237, 0, s[60:61]
  v_cndmask_b32 v132, 0, v237, s[60:61]
  v_cndmask_b32 v5, v237, 0, s[62:63]
  v_cndmask_b32 v133, 0, v237, s[62:63]
  v_cndmask_b32 v6, v237, 0, s[8:9]
  v_cndmask_b32 v134, 0, v237, s[8:9]
  v_cndmask_b32 v7, v237, 0, s[10:11]
  v_cndmask_b32 v135, 0, v237, s[10:11]
  v_cndmask_b32 v8, v237, 0, s[12:13]
  v_cndmask_b32 v136, 0, v237, s[12:13]
  v_cndmask_b32 v9, v237, 0, s[14:15]
  v_cndmask_b32 v137, 0, v237, s[14:15]
  v_cndmask_b32 v10, v237, 0, s[16:17]
  v_cndmask_b32 v138, 0, v237, s[16:17]
  v_cndmask_b32 v11, v237, 0, s[18:19]
  v_cndmask_b32 v139, 0, v237, s[18:19]
  v_cndmask_b32 v12, v237, 0, s[36:37]
  v_cndmask_b32 v140, 0, v237, s[36:37]
  v_cndmask_b32 v13, v237, 0, s[38:39]
  v_cndmask_b32 v141, 0, v237, s[38:39]
  v_cndmask_b32 v14, v237, 0, s[40:41]
  v_cndmask_b32 v142, 0, v237, s[40:41]
  v_cndmask_b32 v15, v237, 0, s[42:43]
  v_cndmask_b32 v143, 0, v237, s[42:43]
  v_mov_b32 v227, 0
  v_mov_b32 v226, 0xf149
  v_cndmask_b32 v226, 0, v226, vcc
  ds_read_b128 v[186:189], v238 offset:10752
  ds_read_b64 v[190:191], v239 offset:10752
  ds_read_b128 v[192:195], v238 offset:12288
  ds_read_b64 v[196:197], v239 offset:12288
  s_waitcnt lgkmcnt(15)
  v_mfma_f32_32x32x16_bf16 v[0:15], v[144:147], v[214:217], v[0:15]
  s_waitcnt lgkmcnt(14)
  v_mfma_f32_32x32x16_bf16 v[16:31], v[150:153], v[214:217], 0
  s_waitcnt lgkmcnt(12)
  v_mfma_f32_32x32x16_bf16 v[32:47], v[156:159], v[214:217], 0
  v_mfma_f32_32x32x8_bf16 v[0:15], v[148:149], v[218:219], v[0:15]
  s_cmp_le_i32 s31, 0
  s_cbranch_scc1 ATT_v2
  v_mfma_f32_32x32x8_bf16 v[0:15], v[248:249], v[226:227], v[0:15]
  s_nop 7
ATT_v2:
  s_waitcnt lgkmcnt(10)
  v_mfma_f32_32x32x16_bf16 v[48:63], v[162:165], v[214:217], 0
  v_mfma_f32_32x32x8_bf16 v[16:31], v[154:155], v[218:219], v[16:31]
  s_cmp_le_i32 s31, 1
  s_cbranch_scc1 ATT_v3
  v_mfma_f32_32x32x8_bf16 v[16:31], v[248:249], v[226:227], v[16:31]
  s_nop 7
ATT_v3:
  s_waitcnt lgkmcnt(8)
  v_mfma_f32_32x32x16_bf16 v[64:79], v[168:171], v[214:217], 0
  s_nop 3
  v_max_f32 v242, v0, v1
  v_max_f32 v243, v2, v3
  v_max_f32 v244, v4, v5
  v_max_f32 v245, v6, v7
  v_mfma_f32_32x32x8_bf16 v[32:47], v[160:161], v[218:219], v[32:47]
  s_cmp_le_i32 s31, 2
  s_cbranch_scc1 ATT_v4
  v_mfma_f32_32x32x8_bf16 v[32:47], v[248:249], v[226:227], v[32:47]
  s_nop 7
ATT_v4:
  v_max3_f32 v242, v8, v9, v242
  v_max3_f32 v243, v10, v11, v243
  v_max3_f32 v244, v12, v13, v244
  v_max3_f32 v245, v14, v15, v245
  s_waitcnt lgkmcnt(6)
  v_mfma_f32_32x32x16_bf16 v[80:95], v[174:177], v[214:217], 0
  v_max3_f32 v242, v16, v17, v242
  v_max3_f32 v243, v18, v19, v243
  v_max3_f32 v244, v20, v21, v244
  v_max3_f32 v245, v22, v23, v245
  v_mfma_f32_32x32x8_bf16 v[48:63], v[166:167], v[218:219], v[48:63]
  s_cmp_le_i32 s31, 3
  s_cbranch_scc1 ATT_v5
  v_mfma_f32_32x32x8_bf16 v[48:63], v[248:249], v[226:227], v[48:63]
  s_nop 7
ATT_v5:
  v_max3_f32 v242, v24, v25, v242
  v_max3_f32 v243, v26, v27, v243
  v_max3_f32 v244, v28, v29, v244
  v_max3_f32 v245, v30, v31, v245
  s_waitcnt lgkmcnt(4)
  v_mfma_f32_32x32x16_bf16 v[96:111], v[180:183], v[214:217], 0
  v_max3_f32 v242, v32, v33, v242
  v_max3_f32 v243, v34, v35, v243
  v_max3_f32 v244, v36, v37, v244
  v_max3_f32 v245, v38, v39, v245
  v_mfma_f32_32x32x8_bf16 v[64:79], v[172:173], v[218:219], v[64:79]
  s_cmp_le_i32 s31, 4
  s_cbranch_scc1 ATT_v6
  v_mfma_f32_32x32x8_bf16 v[64:79], v[248:249], v[226:227], v[64:79]
  s_nop 7
ATT_v6:
  v_max3_f32 v242, v40, v41, v242
  v_max3_f32 v243, v42, v43, v243
  v_max3_f32 v244, v44, v45, v244
  v_max3_f32 v245, v46, v47, v245
  s_waitcnt lgkmcnt(2)
  v_mfma_f32_32x32x16_bf16 v[112:127], v[186:189], v[214:217], 0
  v_max3_f32 v242, v48, v49, v242
  v_max3_f32 v243, v50, v51, v243
  v_max3_f32 v244, v52, v53, v244
  v_max3_f32 v245, v54, v55, v245
  v_mfma_f32_32x32x8_bf16 v[80:95], v[178:179], v[218:219], v[80:95]
  s_cmp_le_i32 s31, 5
  s_cbranch_scc1 ATT_v7
  v_mfma_f32_32x32x8_bf16 v[80:95], v[248:249], v[226:227], v[80:95]
  s_nop 7
ATT_v7:
  v_max3_f32 v242, v56, v57, v242
  v_max3_f32 v243, v58, v59, v243
  v_max3_f32 v244, v60, v61, v244
  v_max3_f32 v245, v62, v63, v245
  s_waitcnt lgkmcnt(0)
  v_mfma_f32_32x32x16_bf16 v[128:143], v[192:195], v[214:217], v[128:143]
  v_max3_f32 v242, v64, v65, v242
  v_max3_f32 v243, v66, v67, v243
  v_max3_f32 v244, v68, v69, v244
  v_max3_f32 v245, v70, v71, v245
  v_mfma_f32_32x32x8_bf16 v[96:111], v[184:185], v[218:219], v[96:111]
  s_cmp_le_i32 s31, 6
  s_cbranch_scc1 ATT_v8
  v_mfma_f32_32x32x8_bf16 v[96:111], v[248:249], v[226:227], v[96:111]
  s_nop 7
ATT_v8:
  v_max3_f32 v242, v72, v73, v242
  v_max3_f32 v243, v74, v75, v243
  v_max3_f32 v244, v76, v77, v244
  v_max3_f32 v245, v78, v79, v245
  v_max3_f32 v242, v80, v81, v242
  v_max3_f32 v243, v82, v83, v243
  v_max3_f32 v244, v84, v85, v244
  v_max3_f32 v245, v86, v87, v245
  v_mfma_f32_32x32x8_bf16 v[112:127], v[190:191], v[218:219], v[112:127]
  s_cmp_le_i32 s31, 7
  s_cbranch_scc1 ATT_v9
  v_mfma_f32_32x32x8_bf16 v[112:127], v[248:249], v[226:227], v[112:127]
  s_nop 7
ATT_v9:
  v_max3_f32 v242, v88, v89, v242
  v_max3_f32 v243, v90, v91, v243
  v_max3_f32 v244, v92, v93, v244
  v_max3_f32 v245, v94, v95, v245
  v_max3_f32 v242, v96, v97, v242
  v_max3_f32 v243, v98, v99, v243
  v_max3_f32 v244, v100, v101, v244
  v_max3_f32 v245, v102, v103, v245
  v_mfma_f32_32x32x8_bf16 v[128:143], v[196:197], v[218:219], v[128:143]
  v_max3_f32 v242, v104, v105, v242
  v_max3_f32 v243, v106, v107, v243
  v_max3_f32 v244, v108, v109, v244
  v_max3_f32 v245, v110, v111, v245
  v_max3_f32 v242, v112, v113, v242
  v_max3_f32 v243, v114, v115, v243
  v_max3_f32 v244, v116, v117, v244
  v_max3_f32 v245, v118, v119, v245
  s_nop 5
  v_max3_f32 v242, v120, v121, v242
  v_max3_f32 v243, v122, v123, v243
  v_max3_f32 v244, v124, v125, v244
  v_max3_f32 v245, v126, v127, v245
  v_max3_f32 v242, v128, v129, v242
  v_max3_f32 v243, v130, v131, v243
  v_max3_f32 v244, v132, v133, v244
  v_max3_f32 v245, v134, v135, v245
  s_nop 5
  v_max3_f32 v242, v136, v137, v242
  v_max3_f32 v243, v138, v139, v243
  v_max3_f32 v244, v140, v141, v244
  v_max3_f32 v245, v142, v143, v245
  ds_read_b64_tr_b16 v[144:145], v240 offset:0
  ds_read_b64_tr_b16 v[146:147], v240 offset:384
  ds_read_b64_tr_b16 v[148:149], v240 offset:768
  ds_read_b64_tr_b16 v[150:151], v240 offset:1152
  ds_read_b64_tr_b16 v[152:153], v240 offset:1536
  ds_read_b64_tr_b16 v[154:155], v240 offset:1920
  ds_read_b64_tr_b16 v[156:157], v240 offset:2304
  ds_read_b64_tr_b16 v[158:159], v240 offset:2688
  ds_read_b64_tr_b16 v[160:161], v240 offset:3072
  ds_read_b64_tr_b16 v[162:163], v240 offset:3456
  ds_read_b64_tr_b16 v[164:165], v240 offset:3840
  ds_read_b64_tr_b16 v[166:167], v240 offset:4224
  v_max3_f32 v242, v242, v243, v244
  v_max_f32 v242, v242, v245
  v_mov_b32 v243, v242
  s_nop 1
  v_permlane32_swap_b32 v242, v243
  s_nop 1
  v_max_f32 v242, v242, v243
  v_cvt_pk_bf16_f32 v243, v242, v242
  v_and_b32 v243, 0xffff0000, v243
  v_sub_f32 v244, v242, v243
  v_cvt_pk_bf16_f32 v244, -v243, -v244
  v_mov_b32 v245, 0
  v_cndmask_b32 v244, 0, v244, vcc
  s_nop 1
  v_mfma_f32_32x32x8_bf16 v[0:15], v[248:249], v[244:245], v[0:15]
  v_mfma_f32_32x32x8_bf16 v[16:31], v[248:249], v[244:245], v[16:31]
  s_nop 7
  s_nop 2
  v_exp_f32 v0, v0
  v_exp_f32 v1, v1
  v_exp_f32 v2, v2
  v_exp_f32 v3, v3
  v_mfma_f32_32x32x8_bf16 v[32:47], v[248:249], v[244:245], v[32:47]
  v_exp_f32 v4, v4
  v_exp_f32 v5, v5
  v_exp_f32 v6, v6
  v_exp_f32 v7, v7
  v_exp_f32 v8, v8
  v_exp_f32 v9, v9
  v_exp_f32 v10, v10
  v_exp_f32 v11, v11
  v_exp_f32 v12, v12
  v_exp_f32 v13, v13
  v_exp_f32 v14, v14
  v_exp_f32 v15, v15
  ds_read_b64_tr_b16 v[168:169], v240 offset:4608
  ds_read_b64_tr_b16 v[170:171], v240 offset:4992
  ds_read_b64_tr_b16 v[172:173], v240 offset:5376
  ds_read_b64_tr_b16 v[174:175], v240 offset:5760
  v_cvt_pk_bf16_f32 v176, v0, v1
  v_cvt_pk_bf16_f32 v177, v2, v3
  v_cvt_pk_bf16_f32 v178, v4, v5
  v_cvt_pk_bf16_f32 v179, v6, v7
  v_cvt_pk_bf16_f32 v180, v8, v9
  v_cvt_pk_bf16_f32 v181, v10, v11
  v_cvt_pk_bf16_f32 v182, v12, v13
  v_cvt_pk_bf16_f32 v183, v14, v15
  s_waitcnt lgkmcnt(12)
  s_nop 0
  v_mfma_f32_32x32x16_bf16 v[198:213], v[144:147], v[176:179], 0
  v_mfma_f32_32x32x16_bf16 v[198:213], v[148:151], v[180:183], v[198:213]
  v_exp_f32 v16, v16
  v_exp_f32 v17, v17
  v_exp_f32 v18, v18
  v_exp_f32 v19, v19
  v_mfma_f32_32x32x8_bf16 v[48:63], v[248:249], v[244:245], v[48:63]
  v_exp_f32 v20, v20
  v_exp_f32 v21, v21
  v_exp_f32 v22, v22
  v_exp_f32 v23, v23
  v_exp_f32 v24, v24
  v_exp_f32 v25, v25
  v_exp_f32 v26, v26
  v_exp_f32 v27, v27
  v_exp_f32 v28, v28
  v_exp_f32 v29, v29
  v_exp_f32 v30, v30
  v_exp_f32 v31, v31
  ds_read_b64_tr_b16 v[144:145], v240 offset:6144
  ds_read_b64_tr_b16 v[146:147], v240 offset:6528
  ds_read_b64_tr_b16 v[148:149], v240 offset:6912
  ds_read_b64_tr_b16 v[150:151], v240 offset:7296
  v_cvt_pk_bf16_f32 v184, v16, v17
  v_cvt_pk_bf16_f32 v185, v18, v19
  v_cvt_pk_bf16_f32 v186, v20, v21
  v_cvt_pk_bf16_f32 v187, v22, v23
  v_cvt_pk_bf16_f32 v188, v24, v25
  v_cvt_pk_bf16_f32 v189, v26, v27
  v_cvt_pk_bf16_f32 v190, v28, v29
  v_cvt_pk_bf16_f32 v191, v30, v31
  s_waitcnt lgkmcnt(12)
  s_nop 0
  v_mfma_f32_32x32x16_bf16 v[198:213], v[152:155], v[184:187], v[198:213]
  v_mfma_f32_32x32x16_bf16 v[198:213], v[156:159], v[188:191], v[198:213]
  v_exp_f32 v32, v32
  v_exp_f32 v33, v33
  v_exp_f32 v34, v34
  v_exp_f32 v35, v35
  v_mfma_f32_32x32x8_bf16 v[64:79], v[248:249], v[244:245], v[64:79]
  v_exp_f32 v36, v36
  v_exp_f32 v37, v37
  v_exp_f32 v38, v38
  v_exp_f32 v39, v39
  v_exp_f32 v40, v40
  v_exp_f32 v41, v41
  v_exp_f32 v42, v42
  v_exp_f32 v43, v43
  v_exp_f32 v44, v44
  v_exp_f32 v45, v45
  v_exp_f32 v46, v46
  v_exp_f32 v47, v47
  ds_read_b64_tr_b16 v[152:153], v240 offset:7680
  ds_read_b64_tr_b16 v[154:155], v240 offset:8064
  ds_read_b64_tr_b16 v[156:157], v240 offset:8448
  ds_read_b64_tr_b16 v[158:159], v240 offset:8832
  v_cvt_pk_bf16_f32 v176, v32, v33
  v_cvt_pk_bf16_f32 v177, v34, v35
  v_cvt_pk_bf16_f32 v178, v36, v37
  v_cvt_pk_bf16_f32 v179, v38, v39
  v_cvt_pk_bf16_f32 v180, v40, v41
  v_cvt_pk_bf16_f32 v181, v42, v43
  v_cvt_pk_bf16_f32 v182, v44, v45
  v_cvt_pk_bf16_f32 v183, v46, v47
  s_waitcnt lgkmcnt(12)
  s_nop 0
  v_mfma_f32_32x32x16_bf16 v[198:213], v[160:163], v[176:179], v[198:213]
  v_mfma_f32_32x32x16_bf16 v[198:213], v[164:167], v[180:183], v[198:213]
  v_exp_f32 v48, v48
  v_exp_f32 v49, v49
  v_exp_f32 v50, v50
  v_exp_f32 v51, v51
  v_mfma_f32_32x32x8_bf16 v[80:95], v[248:249], v[244:245], v[80:95]
  v_exp_f32 v52, v52
  v_exp_f32 v53, v53
  v_exp_f32 v54, v54
  v_exp_f32 v55, v55
  v_exp_f32 v56, v56
  v_exp_f32 v57, v57
  v_exp_f32 v58, v58
  v_exp_f32 v59, v59
  v_exp_f32 v60, v60
  v_exp_f32 v61, v61
  v_exp_f32 v62, v62
  v_exp_f32 v63, v63
  ds_read_b64_tr_b16 v[160:161], v240 offset:9216
  ds_read_b64_tr_b16 v[162:163], v240 offset:9600
  ds_read_b64_tr_b16 v[164:165], v240 offset:9984
  ds_read_b64_tr_b16 v[166:167], v240 offset:10368
  v_cvt_pk_bf16_f32 v184, v48, v49
  v_cvt_pk_bf16_f32 v185, v50, v51
  v_cvt_pk_bf16_f32 v186, v52, v53
  v_cvt_pk_bf16_f32 v187, v54, v55
  v_cvt_pk_bf16_f32 v188, v56, v57
  v_cvt_pk_bf16_f32 v189, v58, v59
  v_cvt_pk_bf16_f32 v190, v60, v61
  v_cvt_pk_bf16_f32 v191, v62, v63
  s_waitcnt lgkmcnt(12)
  s_nop 0
  v_mfma_f32_32x32x16_bf16 v[198:213], v[168:171], v[184:187], v[198:213]
  v_mfma_f32_32x32x16_bf16 v[198:213], v[172:175], v[188:191], v[198:213]
  v_exp_f32 v64, v64
  v_exp_f32 v65, v65
  v_exp_f32 v66, v66
  v_exp_f32 v67, v67
  v_mfma_f32_32x32x8_bf16 v[96:111], v[248:249], v[244:245], v[96:111]
  v_exp_f32 v68, v68
  v_exp_f32 v69, v69
  v_exp_f32 v70, v70
  v_exp_f32 v71, v71
  v_exp_f32 v72, v72
  v_exp_f32 v73, v73
  v_exp_f32 v74, v74
  v_exp_f32 v75, v75
  v_exp_f32 v76, v76
  v_exp_f32 v77, v77
  v_exp_f32 v78, v78
  v_exp_f32 v79, v79
  ds_read_b64_tr_b16 v[168:169], v240 offset:10752
  ds_read_b64_tr_b16 v[170:171], v240 offset:11136
  ds_read_b64_tr_b16 v[172:173], v240 offset:11520
  ds_read_b64_tr_b16 v[174:175], v240 offset:11904
  v_cvt_pk_bf16_f32 v176, v64, v65
  v_cvt_pk_bf16_f32 v177, v66, v67
  v_cvt_pk_bf16_f32 v178, v68, v69
  v_cvt_pk_bf16_f32 v179, v70, v71
  v_cvt_pk_bf16_f32 v180, v72, v73
  v_cvt_pk_bf16_f32 v181, v74, v75
  v_cvt_pk_bf16_f32 v182, v76, v77
  v_cvt_pk_bf16_f32 v183, v78, v79
  s_waitcnt lgkmcnt(12)
  s_nop 0
  v_mfma_f32_32x32x16_bf16 v[198:213], v[144:147], v[176:179], v[198:213]
  v_mfma_f32_32x32x16_bf16 v[198:213], v[148:151], v[180:183], v[198:213]
  v_exp_f32 v80, v80
  v_exp_f32 v81, v81
  v_exp_f32 v82, v82
  v_exp_f32 v83, v83
  v_mfma_f32_32x32x8_bf16 v[112:127], v[248:249], v[244:245], v[112:127]
  v_exp_f32 v84, v84
  v_exp_f32 v85, v85
  v_exp_f32 v86, v86
  v_exp_f32 v87, v87
  v_exp_f32 v88, v88
  v_exp_f32 v89, v89
  v_exp_f32 v90, v90
  v_exp_f32 v91, v91
  v_exp_f32 v92, v92
  v_exp_f32 v93, v93
  v_exp_f32 v94, v94
  v_exp_f32 v95, v95
  ds_read_b64_tr_b16 v[144:145], v240 offset:12288
  ds_read_b64_tr_b16 v[146:147], v240 offset:12672
  ds_read_b64_tr_b16 v[148:149], v240 offset:13056
  ds_read_b64_tr_b16 v[150:151], v240 offset:13440
  v_cvt_pk_bf16_f32 v184, v80, v81
  v_cvt_pk_bf16_f32 v185, v82, v83
  v_cvt_pk_bf16_f32 v186, v84, v85
  v_cvt_pk_bf16_f32 v187, v86, v87
  v_cvt_pk_bf16_f32 v188, v88, v89
  v_cvt_pk_bf16_f32 v189, v90, v91
  v_cvt_pk_bf16_f32 v190, v92, v93
  v_cvt_pk_bf16_f32 v191, v94, v95
  s_waitcnt lgkmcnt(12)
  s_nop 0
  v_mfma_f32_32x32x16_bf16 v[198:213], v[152:155], v[184:187], v[198:213]
  v_mfma_f32_32x32x16_bf16 v[198:213], v[156:159], v[188:191], v[198:213]
  v_exp_f32 v96, v96
  v_exp_f32 v97, v97
  v_exp_f32 v98, v98
  v_exp_f32 v99, v99
  v_mfma_f32_32x32x8_bf16 v[128:143], v[248:249], v[244:245], v[128:143]
  v_exp_f32 v100, v100
  v_exp_f32 v101, v101
  v_exp_f32 v102, v102
  v_exp_f32 v103, v103
  v_exp_f32 v104, v104
  v_exp_f32 v105, v105
  v_exp_f32 v106, v106
  v_exp_f32 v107, v107
  v_exp_f32 v108, v108
  v_exp_f32 v109, v109
  v_exp_f32 v110, v110
  v_exp_f32 v111, v111
  s_nop 0
  v_cvt_pk_bf16_f32 v176, v96, v97
  v_cvt_pk_bf16_f32 v177, v98, v99
  v_cvt_pk_bf16_f32 v178, v100, v101
  v_cvt_pk_bf16_f32 v179, v102, v103
  v_cvt_pk_bf16_f32 v180, v104, v105
  v_cvt_pk_bf16_f32 v181, v106, v107
  v_cvt_pk_bf16_f32 v182, v108, v109
  v_cvt_pk_bf16_f32 v183, v110, v111
  s_waitcnt lgkmcnt(8)
  s_nop 0
  v_mfma_f32_32x32x16_bf16 v[198:213], v[160:163], v[176:179], v[198:213]
  v_mfma_f32_32x32x16_bf16 v[198:213], v[164:167], v[180:183], v[198:213]
  v_exp_f32 v112, v112
  v_exp_f32 v113, v113
  v_exp_f32 v114, v114
  v_exp_f32 v115, v115
  v_exp_f32 v116, v116
  v_exp_f32 v117, v117
  v_exp_f32 v118, v118
  v_exp_f32 v119, v119
  v_exp_f32 v120, v120
  v_exp_f32 v121, v121
  v_exp_f32 v122, v122
  v_exp_f32 v123, v123
  v_exp_f32 v124, v124
  v_exp_f32 v125, v125
  v_exp_f32 v126, v126
  v_exp_f32 v127, v127
  s_nop 0
  v_cvt_pk_bf16_f32 v184, v112, v113
  v_cvt_pk_bf16_f32 v185, v114, v115
  v_cvt_pk_bf16_f32 v186, v116, v117
  v_cvt_pk_bf16_f32 v187, v118, v119
  v_cvt_pk_bf16_f32 v188, v120, v121
  v_cvt_pk_bf16_f32 v189, v122, v123
  v_cvt_pk_bf16_f32 v190, v124, v125
  v_cvt_pk_bf16_f32 v191, v126, v127
  s_waitcnt lgkmcnt(4)
  s_nop 0
  v_mfma_f32_32x32x16_bf16 v[198:213], v[168:171], v[184:187], v[198:213]
  v_mfma_f32_32x32x16_bf16 v[198:213], v[172:175], v[188:191], v[198:213]
  v_exp_f32 v128, v128
  v_exp_f32 v129, v129
  v_exp_f32 v130, v130
  v_exp_f32 v131, v131
  v_exp_f32 v132, v132
  v_exp_f32 v133, v133
  v_exp_f32 v134, v134
  v_exp_f32 v135, v135
  v_exp_f32 v136, v136
  v_exp_f32 v137, v137
  v_exp_f32 v138, v138
  v_exp_f32 v139, v139
  v_exp_f32 v140, v140
  v_exp_f32 v141, v141
  v_exp_f32 v142, v142
  v_exp_f32 v143, v143
  s_nop 0
  v_cvt_pk_bf16_f32 v176, v128, v129
  v_cvt_pk_bf16_f32 v177, v130, v131
  v_cvt_pk_bf16_f32 v178, v132, v133
  v_cvt_pk_bf16_f32 v179, v134, v135
  v_cvt_pk_bf16_f32 v180, v136, v137
  v_cvt_pk_bf16_f32 v181, v138, v139
  v_cvt_pk_bf16_f32 v182, v140, v141
  v_cvt_pk_bf16_f32 v183, v142, v143
  s_waitcnt lgkmcnt(0)
  s_nop 0
  v_mfma_f32_32x32x16_bf16 v[198:213], v[144:147], v[176:179], v[198:213]
  v_mfma_f32_32x32x16_bf16 v[198:213], v[148:151], v[180:183], v[198:213]
  s_nop 7
  s_nop 4
  v_rcp_f32 v242, v210
  v_mov_b32 v226, v228
  v_mov_b32 v227, v229
  v_pk_mul_f32 v[198:199], v[198:199], v[242:243] op_sel_hi:[1,0]
  v_pk_mul_f32 v[200:201], v[200:201], v[242:243] op_sel_hi:[1,0]
  v_pk_mul_f32 v[202:203], v[202:203], v[242:243] op_sel_hi:[1,0]
  v_pk_mul_f32 v[204:205], v[204:205], v[242:243] op_sel_hi:[1,0]
  v_pk_mul_f32 v[206:207], v[206:207], v[242:243] op_sel_hi:[1,0]
  v_pk_mul_f32 v[208:209], v[208:209], v[242:243] op_sel_hi:[1,0]
  v_cvt_pk_bf16_f32 v192, v198, v199
  v_cvt_pk_bf16_f32 v193, v200, v201
  v_cvt_pk_bf16_f32 v194, v202, v203
  v_cvt_pk_bf16_f32 v195, v204, v205
  v_cvt_pk_bf16_f32 v228, v206, v207
  v_cvt_pk_bf16_f32 v229, v208, v209
  buffer_store_dwordx4 v[192:195], v233, s[4:7], 0 offen sc1
  v_mov_b32 v214, v220
  v_mov_b32 v215, v221
  v_mov_b32 v216, v222
  v_mov_b32 v217, v223
  v_mov_b32 v218, v224
  v_mov_b32 v219, v225
  v_add_u32 v233, 768, v233
  v_add_u32 v238, 36864, v238
  v_add_u32 v239, 36864, v239
  v_mov_b32 v240, v247
  s_add_u32 s35, s35, 1
  s_cmp_lt_u32 s35, 2
  s_cbranch_scc1 ATT_u
  buffer_store_dwordx4 v[226:229], v235, s[4:7], 0 offen offset:512 sc1
  v_mov_b32 v242, 73728
  v_mov_b32 v243, 1
  s_waitcnt vmcnt(0)

  s_mov_b64 exec, 1
  ds_add_rtn_u32 v243, v242, v243 offset:4
  s_mov_b64 exec, -1
  s_waitcnt lgkmcnt(0)
  v_readfirstlane_b32 s3, v243
  s_cmp_lg_u32 s3, 3
  s_cbranch_scc1 K1_exit
  s_lshl_b32 s3, s22, 4
  s_add_u32 s3, s3, s21
  s_mov_b32 s20, 4
  v_cmp_eq_u32 vcc, 0, v251
  v_mov_b32 v230, 0x40000000
  s_lshl_b32 s26, s3, 7
  s_add_u32 s26, s26, 81920
  s_cmp_eq_u32 s20, 4
  s_cselect_b32 s26, s26, 0x40000000
  v_mov_b32 v231, s82
  v_cndmask_b32 v230, v230, 0, vcc
  buffer_store_dword v231, v230, s[64:67], s26 offen sc1
  v_and_b32 v230, 15, v251
  s_lshr_b32 s3, s50, 1
  s_lshl_b32 s3, s3, 4
  v_add_u32 v230, s3, v230
  v_lshlrev_b32 v230, 7, v230
  s_mov_b32 s26, 0x100000
  s_mov_b32 s83, 81920
FPO2_loop:
  buffer_load_dword v231, v230, s[64:67], s83 offen sc1
  s_sub_u32 s26, s26, 1
  s_cbranch_scc1 FPO2_done
  s_waitcnt vmcnt(0)
  v_cmp_ne_u32 vcc, s82, v231
  s_cbranch_vccz FPO2_done
  s_sleep 1
  s_branch FPO2_loop
FPO2_done:
  v_mov_b32 v243, 1
  ds_write_b32 v242, v243 offset:8
  s_waitcnt lgkmcnt(0)
  s_endpgm
K1_exit:
  s_endpgm
.section .rodata,"a"
.p2align 6
.amdhsa_kernel parallel_sum__sliding_block__geglu_ffn__prompt_kernel
  .amdhsa_next_free_vgpr 252
  .amdhsa_next_free_sgpr 100
  .amdhsa_accum_offset 252
  .amdhsa_group_segment_fixed_size 0
  .amdhsa_kernarg_size 80
  .amdhsa_user_sgpr_count 2
  .amdhsa_user_sgpr_kernarg_segment_ptr 1
  .amdhsa_system_sgpr_workgroup_id_x 1
.end_amdhsa_kernel
```
